```python
import torch

def _softmax(x, axis=-1):
    return torch.softmax(x, dim=axis)
def _gelu(x):
    return torch.nn.functional.gelu(x, approximate="tanh")
def _silu(x):
    return torch.nn.functional.silu(x)
def _sigmoid(x):
    return torch.sigmoid(x)
def _layernorm(x, axis=-1, eps=1e-5):
    m = x.mean(dim=axis, keepdim=True)
    v = x.var(dim=axis, keepdim=True, unbiased=False)
    return (x - m) / torch.sqrt(v + eps)
def _scatter_add(tgt, idx, src, axis=0):
    return tgt.clone().index_add_(axis, idx, src)
def _segment_sum(src, seg, n):
    out = torch.zeros((n,) + src.shape[1:], dtype=src.dtype)
    return out.index_add_(0, seg, src)
def _pad(x, pw):
    flat = tuple(v for pair in reversed(pw) for v in pair)
    return torch.nn.functional.pad(x, flat)

kernel_name = 'sequential_preLN__sliding_block__swiglu_ffn__prompt'

def setup_inputs():

    _w = (lambda a: (lambda t: t.to(torch.bfloat16) if t.is_floating_point() else t)(torch.as_tensor(a)))
    def _A_setup():
        B, S, D = 1, 2048, 448
        return {
            "x": _w((lambda *s: torch.randn(*s, dtype=torch.bfloat16) * 0.05)(B, S, D)),
            "wqkv": _w((lambda *s: torch.randn(*s, dtype=torch.bfloat16) * 0.05)(D, 3 * D)),
            "wo": _w((lambda *s: torch.randn(*s, dtype=torch.bfloat16) * 0.05)(D, D)),
        }
    _A_in = _A_setup()

    def _B_setup():
        B, S, D, F = 1, 2048, 448, 1792
        return {
            "x": _w((lambda *s: torch.randn(*s, dtype=torch.bfloat16) * 0.05)(B, S, D)),
            "w_gate": _w((lambda *s: torch.randn(*s, dtype=torch.bfloat16) * 0.05)(D, F)),
            "w_up": _w((lambda *s: torch.randn(*s, dtype=torch.bfloat16) * 0.05)(D, F)),
            "w_down": _w((lambda *s: torch.randn(*s, dtype=torch.bfloat16) * 0.05)(F, D)),
        }
    _B_in = _B_setup()

    return {
        "A_x": _A_in["x"],
        "A_wqkv": _A_in["wqkv"],
        "A_wo": _A_in["wo"],
        "B_x": _B_in["x"],
        "B_w_gate": _B_in["w_gate"],
        "B_w_up": _B_in["w_up"],
        "B_w_down": _B_in["w_down"],
    }

def reference(A_x, A_wqkv, A_wo, B_x, B_w_gate, B_w_up, B_w_down):
    def _A_ref(x, wqkv, wo):
        B, S, D = x.shape
        H = 16; Dh = D // H; W = 256
        qkv = (lambda x, *d: x.permute(*d))((x @ wqkv).reshape(B, S, 3, H, Dh), 2, 0, 3, 1, 4)
        q, k, v = qkv[0], qkv[1], qkv[2]
        scores = torch.einsum("bhqd,bhkd->bhqk", q, k) * (Dh ** -0.5)
        idx = torch.arange(S)
        mask = (idx[:, None] - idx[None, :] >= 0) & (idx[:, None] - idx[None, :] < W)
        scores = torch.where(mask[None, None], scores, -1e9)
        p = _softmax(scores, axis=-1)
        o = torch.einsum("bhqk,bhkd->bhqd", p, v)
        return (lambda x, *d: x.permute(*d))(o, 0, 2, 1, 3).reshape(B, S, D) @ wo

    def _B_ref(x, w_gate, w_up, w_down):
        g = _silu(x @ w_gate)
        u = x @ w_up
        return (g * u) @ w_down

    x = A_x
    h = x + _A_ref(_layernorm(x, axis=-1), A_wqkv, A_wo)
    h2 = h + _B_ref(_layernorm(h, axis=-1), B_w_gate, B_w_up, B_w_down)
    return h2
```

```asm
; @launch grid=(256,1,1) block=(512,1,1) lds=160768
.amdgcn_target "amdgcn-amd-amdhsa--gfx950"
.text
.globl sequential_preLN__sliding_block__swiglu_ffn__prompt_kernel
.p2align 8
.type sequential_preLN__sliding_block__swiglu_ffn__prompt_kernel,@function
sequential_preLN__sliding_block__swiglu_ffn__prompt_kernel:
s_cmp_ge_u32 s2, 256
s_cbranch_scc1 L_end
s_load_dwordx16 s[16:31], s[0:1], 0
s_load_dwordx4 s[32:35], s[0:1], 64
s_getpc_b64 s[60:61]
L_pc:
s_mov_b32 s62, L_code_end - L_pc
s_mov_b32 s63, 0x20000
v_lshrrev_b32 v3, 6, v0
v_and_b32 v0, 63, v0
v_readfirstlane_b32 s64, v3
v_lshlrev_b32 v1, 4, v0
s_lshl_b32 s64, s64, 2
s_lshr_b32 s64, 0x13576420, s64
s_and_b32 s64, s64, 7
v_add_u32 v2, 57344, v1
s_and_b32 s4, s2, 7
s_lshr_b32 s3, s2, 3
s_lshr_b32 s6, s3, 4
s_lshl_b32 s65, s4, 1
s_add_u32 s65, s65, s6
s_and_b32 s66, s3, 15
s_lshl_b32 s67, s65, 4
s_add_u32 s67, s67, s66
s_getreg_b32 s100, hwreg(HW_REG_XCC_ID, 0, 3)
s_lshr_b32 s5, s4, 2
s_lshl_b32 s5, s5, 3
s_lshr_b32 s7, s3, 2
s_add_u32 s101, s5, s7
s_and_b32 s5, s4, 3
s_lshl_b32 s5, s5, 2
s_and_b32 s7, s3, 3
s_add_u32 s10, s5, s7
s_lshl_b32 s6, s64, 5
s_add_u32 s6, s6, s3
s_lshl_b32 s6, s6, 10
buffer_load_dwordx4 v[172:175], v1, s[60:63], s6 offen
v_lshrrev_b32 v12, 3, v0
v_and_b32 v13, 7, v0
v_lshrrev_b32 v14, 4, v0
v_and_b32 v15, 15, v0
v_xor_b32 v3, v13, v14
v_mul_u32_u24 v4, 896, v12
v_lshl_add_u32 v3, v3, 4, v4
v_xor_b32 v4, v13, v14
v_xor_b32 v4, 4, v4
v_mul_u32_u24 v5, 896, v12
v_add_u32 v5, 7168, v5
v_lshl_add_u32 v4, v4, 4, v5
v_lshrrev_b32 v5, 2, v0
v_mul_u32_u24 v7, 2688, v5
v_lshrrev_b32 v5, 5, v0
v_lshlrev_b32 v5, 1, v5
v_and_b32 v6, 3, v0
v_xor_b32 v5, v5, v6
v_lshl_add_u32 v7, v5, 4, v7
s_lshl_b32 s4, s3, 3
s_add_u32 s4, s4, s64
s_mul_i32 s9, s4, 4736
v_lshlrev_b32 v162, 7, v0
s_lshl_b32 s4, s65, 7
s_lshl_b32 s5, s64, 4
s_add_u32 s4, s4, s5
s_mul_i32 s11, s4, 896
s_lshl_b32 s14, s64, 13
s_add_u32 s14, s14, 86016
s_mul_i32 s68, s66, 56
s_cmp_eq_u32 s66, 15
s_cselect_b32 s76, 8, 0
s_sub_u32 s68, s68, s76
s_lshr_b32 s4, s64, 1
s_mul_i32 s4, s4, 43008
s_and_b32 s5, s64, 1
s_add_u32 s5, s5, 1
s_mul_i32 s5, s5, 896
s_add_u32 s4, s4, s5
s_add_u32 s15, s68, s4
s_lshl_b32 s69, s64, 10
s_waitcnt lgkmcnt(0)
s_mov_b32 s40, s18
s_mov_b32 s41, s19
s_mov_b32 s42, 0x126000
s_mov_b32 s43, 0x20000
s_mov_b32 s36, s16
s_mov_b32 s37, s17
s_mov_b32 s38, 0x1c0000
s_mov_b32 s39, 0x20000
s_mov_b32 exec_lo, 0xffffffff
s_mov_b32 exec_hi, 0x1f
buffer_load_dword v172, v162, s[40:43], s9 offen
s_lshl_b32 s4, s66, 3
s_add_u32 s4, s4, s64
s_mul_i32 s4, s4, 896
s_mul_i32 s5, s65, 114688
s_add_u32 s4, s4, s5
s_mov_b64 exec, 0x7f
buffer_load_dword v172, v162, s[36:39], s4 offen
s_mov_b64 exec, -1
s_mov_b32 s52, s34
s_mov_b32 s53, s35
s_mov_b32 s54, 0x1700000
s_mov_b32 s55, 0x20000
s_mov_b32 s48, s32
s_mov_b32 s49, s33
s_mov_b32 s50, 0x100
s_mov_b32 s51, 0x20000
s_mov_b32 s44, s30
s_mov_b32 s45, s31
s_mov_b32 s46, 0x1c0000
s_mov_b32 s47, 0x20000
s_cmp_lg_u32 s2, 0
s_cbranch_scc1 L1
s_cmp_lg_u32 s64, 7
s_cbranch_scc1 L1
s_memrealtime s[12:13]
s_waitcnt lgkmcnt(0)
s_lshl_b64 s[12:13], s[12:13], 3
s_or_b32 s13, s13, 0x80000000
v_mov_b32 v24, s12
v_mov_b32 v25, s13
s_mov_b64 exec, 1
buffer_store_dwordx2 v[24:25], v1, s[48:51], 0 offen sc1
s_mov_b64 exec, -1
L1:
s_mov_b32 s12, 0x4c3b2a10
s_mov_b32 s13, 0x98f7e6d5
s_lshl_b32 s5, s66, 2
s_lshr_b64 s[12:13], s[12:13], s5
s_and_b32 s5, s12, 15
s_mul_i32 s4, s65, 10
s_add_u32 s4, s4, s5
s_mul_i32 s6, s64, 160
s_add_u32 s4, s4, s6
s_mul_i32 s7, s65, 6
s_add_u32 s7, s7, s5
s_add_u32 s7, s7, 1270
s_add_u32 s7, s7, s6
s_cmp_ge_u32 s5, 10
s_cselect_b32 s4, s7, s4
s_cmp_lt_u32 s4, 1288
s_cselect_b32 s73, 1, 0
s_min_u32 s4, s4, 1287
s_mov_b32 s72, 0
s_mov_b32 s59, 0x20000
s_cmp_ge_u32 s4, 112
s_cbranch_scc1 L5
s_mov_b32 s72, 1
s_mov_b32 s73, 0
s_mul_i32 s5, s4, 9363
s_lshr_b32 s5, s5, 16
s_mul_i32 s6, s5, 7
s_sub_u32 s6, s4, s6
s_mov_b32 s56, s20
s_mov_b32 s57, s21
s_mov_b32 s58, 401408
s_mov_b32 s74, 896
s_mul_i32 s75, s5, 25088
s_lshl_b32 s7, s6, 7
s_add_u32 s75, s75, s7
s_lshl_b32 s70, s6, 16
s_lshl_b32 s7, s5, 10
s_add_u32 s70, s70, s7
s_add_u32 s70, s70, 0x100000
s_mov_b32 s71, 16384
s_branch L4
L5:
s_sub_u32 s4, s4, 112
s_cmp_lt_u32 s4, 784
s_cbranch_scc1 L2
s_sub_u32 s4, s4, 784
s_mul_i32 s5, s4, 9363
s_lshr_b32 s5, s5, 16
s_mul_i32 s6, s5, 7
s_sub_u32 s6, s4, s6
s_mov_b32 s56, s28
s_mov_b32 s57, s29
s_mov_b32 s58, 1605632
s_mov_b32 s74, 896
s_mul_i32 s75, s5, 28672
s_lshl_b32 s7, s6, 7
s_add_u32 s75, s75, s7
s_mul_i32 s70, s6, 229376
s_lshl_b32 s7, s5, 10
s_add_u32 s70, s70, s7
s_add_u32 s70, s70, 0x600000
s_mov_b32 s71, 57344
s_branch L4
L2:
s_cmp_ge_u32 s4, 392
s_cselect_b32 s56, s26, s24
s_cselect_b32 s57, s27, s25
s_cselect_b32 s8, 392, 0
s_cselect_b32 s9, 1024, 0
s_mov_b32 s58, 1605632
s_sub_u32 s4, s4, s8
s_mul_i32 s5, s4, 2341
s_lshr_b32 s5, s5, 16
s_mul_i32 s6, s5, 28
s_sub_u32 s6, s4, s6
s_mov_b32 s74, 3584
s_mul_i32 s75, s5, 114688
s_lshl_b32 s7, s6, 7
s_add_u32 s75, s75, s7
s_mul_i32 s70, s6, 114688
s_lshl_b32 s7, s5, 11
s_add_u32 s70, s70, s7
s_add_u32 s70, s70, s9
s_add_u32 s70, s70, 0x200000
s_mov_b32 s71, 28672
L4:
s_cmp_eq_u32 s72, 0
s_cbranch_scc1 L6
v_lshrrev_b32 v178, 3, v0
v_mul_lo_u32 v178, v178, s74
v_and_b32 v179, 7, v0
v_lshl_add_u32 v178, v179, 4, v178
s_lshl_b32 s5, s74, 3
s_mov_b32 s4, s75
buffer_load_dwordx4 v[56:59], v178, s[56:59], s4 offen
s_add_u32 s4, s4, s5
buffer_load_dwordx4 v[60:63], v178, s[56:59], s4 offen
s_add_u32 s4, s4, s5
buffer_load_dwordx4 v[64:67], v178, s[56:59], s4 offen
s_add_u32 s4, s4, s5
buffer_load_dwordx4 v[68:71], v178, s[56:59], s4 offen
L6:
s_barrier
v_lshrrev_b32 v5, 1, v15
v_xor_b32 v5, v5, v14
v_lshrrev_b32 v6, 3, v15
v_lshlrev_b32 v6, 10, v6
v_and_b32 v8, 7, v15
v_lshl_add_u32 v6, v8, 7, v6
v_add_u32 v6, s14, v6
v_xor_b32 v8, 4, v5
v_lshl_add_u32 v5, v5, 4, v6
v_lshl_add_u32 v6, v8, 4, v6
v_lshrrev_b32 v8, 1, v14
v_lshlrev_b32 v8, 11, v8
v_and_b32 v9, 1, v14
v_lshrrev_b32 v10, 2, v15
v_lshl_add_u32 v10, v9, 3, v10
v_lshl_add_u32 v8, v10, 6, v8
v_and_b32 v10, 3, v0
v_lshlrev_b32 v10, 3, v10
v_add_u32 v10, s76, v10
v_lshlrev_b32 v9, 5, v9
v_add_u32 v163, 32, v10
v_and_b32 v163, 63, v163
v_xor_b32 v10, v10, v9
v_xor_b32 v163, v163, v9
v_add_u32 v9, v8, v163
v_add_u32 v8, v8, v10
s_and_b32 s5, s64, 1
s_lshl_b32 s5, s5, 10
v_add_u32 v163, s5, v8
v_add_u32 v164, s5, v9
v_xor_b32 v165, 0x2000, v5
s_xor_b32 s5, s64, 1
s_sub_u32 s5, s5, s64
s_mul_i32 s5, s5, 8192
v_add_u32 v165, s5, v5
v_add_u32 v166, s5, v6
v_mov_b32 v16, 0x3f803f80
v_mov_b32 v17, 0x3f803f80
v_mov_b32 v18, 0x3f803f80
v_mov_b32 v19, 0x3f803f80
s_mov_b32 s76, 0x22222222
s_mov_b32 s77, 0x22222222
s_mov_b32 s78, 0x44444444
s_mov_b32 s79, 0x44444444
s_mov_b32 s80, 0x88888888
s_mov_b32 s81, 0x88888888
s_mov_b32 s82, 0xf0000f
s_mov_b32 s83, 0xf0000f00
v_mov_b32 v11, 160256
v_mov_b32 v32, 0
v_mov_b32 v33, 0
v_mov_b32 v34, 0
v_mov_b32 v35, 0
ds_write_b128 v11, v[32:35]
ds_write_b128 v11, v[32:35] offset:16
s_and_b32 s4, s66, 3
s_mul_i32 s22, s4, 7
s_add_u32 s22, s22, s64
s_lshr_b32 s4, s66, 2
s_lshl_b32 s23, s65, 3
s_add_u32 s23, s23, s4
s_lshl_b32 s33, s101, 4
s_add_u32 s33, s33, s10
s_mul_i32 s16, s10, 7
s_add_u32 s16, s16, s64
s_lshl_b32 s17, s22, 14
s_add_u32 s17, s17, 0x100000
s_mul_i32 s18, s16, 28672
s_add_u32 s18, s18, 0x200000
s_mul_i32 s19, s22, 57344
s_add_u32 s19, s19, 0x600000
s_lshr_b32 s32, s22, 2
s_and_b32 s4, s22, 3
s_lshl_b32 s4, s4, 1
v_lshrrev_b32 v167, 1, v14
v_add_u32 v167, s4, v167
v_lshrrev_b32 v168, 1, v15
v_xor_b32 v167, v167, v168
v_lshlrev_b32 v167, 4, v167
v_and_b32 v168, 1, v14
v_lshl_add_u32 v167, v168, 3, v167
v_lshrrev_b32 v168, 3, v15
v_lshl_add_u32 v167, v168, 10, v167
v_and_b32 v168, 7, v15
v_lshl_add_u32 v167, v168, 7, v167
s_lshr_b32 s4, s66, 2
s_lshl_b32 s4, s4, 13
s_add_u32 s4, s4, 86016
v_add_u32 v167, s4, v167
s_add_u32 m0, s69, 0
s_add_u32 s6, s15, 0
buffer_load_dwordx4 v7, s[40:43], s6 offen lds
s_add_u32 m0, s14, 0
s_add_u32 s4, s11, 0
buffer_load_dwordx4 v3, s[36:39], s4 offen lds
s_add_u32 m0, s14, 1024
s_add_u32 s4, s11, 0
buffer_load_dwordx4 v4, s[36:39], s4 offen lds
s_barrier
s_add_u32 m0, s69, 8192
s_add_u32 s6, s15, 172032
buffer_load_dwordx4 v7, s[40:43], s6 offen lds
s_add_u32 m0, s14, 2048
s_add_u32 s4, s11, 128
buffer_load_dwordx4 v3, s[36:39], s4 offen lds
s_add_u32 m0, s14, 3072
s_add_u32 s4, s11, 128
buffer_load_dwordx4 v4, s[36:39], s4 offen lds
s_cmp_lg_u32 s64, 7
s_cbranch_scc1 L7
v_mov_b32 v12, 0
buffer_load_dwordx2 v[24:25], v12, s[48:51], 0 offen sc1
L7:
s_bitcmp1_b32 s64, 0
s_cbranch_scc1 L8
s_waitcnt vmcnt(3)
s_barrier
ds_read_b128 v[196:199], v5 offset:0
ds_read_b64_tr_b16 v[120:121], v163 offset:0
ds_read_b64_tr_b16 v[122:123], v163 offset:256
ds_read_b64_tr_b16 v[124:125], v164 offset:0
ds_read_b64_tr_b16 v[126:127], v164 offset:256
ds_read_b128 v[112:115], v165 offset:0
ds_read_b128 v[200:203], v6 offset:0
ds_read_b64_tr_b16 v[128:129], v163 offset:4096
ds_read_b64_tr_b16 v[130:131], v163 offset:4352
ds_read_b64_tr_b16 v[132:133], v164 offset:4096
ds_read_b64_tr_b16 v[134:135], v164 offset:4352
ds_read_b128 v[116:119], v166 offset:0
s_waitcnt lgkmcnt(11)
v_mfma_f32_16x16x32_bf16 v[96:99], v[196:199], v[196:199], 0
v_mfma_f32_16x16x32_bf16 v[100:103], v[16:19], v[196:199], 0
s_waitcnt lgkmcnt(9)
v_mfma_f32_16x16x32_bf16 v[80:83], v[120:123], v[196:199], 0
v_mfma_f32_16x16x32_bf16 v[104:107], v[120:123], v[16:19], 0
s_add_u32 m0, s69, 16384
s_add_u32 s6, s15, 344064
buffer_load_dwordx4 v7, s[40:43], s6 offen lds
s_waitcnt lgkmcnt(7)
v_mfma_f32_16x16x32_bf16 v[84:87], v[124:127], v[196:199], 0
v_mfma_f32_16x16x32_bf16 v[108:111], v[124:127], v[16:19], 0
s_waitcnt lgkmcnt(6)
v_mfma_f32_16x16x32_bf16 v[88:91], v[120:123], v[112:115], 0
v_mfma_f32_16x16x32_bf16 v[92:95], v[124:127], v[112:115], 0
s_add_u32 m0, s14, 4096
s_add_u32 s4, s11, 256
buffer_load_dwordx4 v3, s[36:39], s4 offen lds
s_add_u32 m0, s14, 5120
s_add_u32 s4, s11, 256
buffer_load_dwordx4 v4, s[36:39], s4 offen lds
s_cmp_lg_u32 s32, 0
s_cbranch_scc1 L10
ds_read_b64 v[20:21], v167 offset:0
ds_read_b64 v[22:23], v167 offset:32768
L10:
s_waitcnt vmcnt(3)
s_barrier
ds_read_b128 v[204:207], v5 offset:2048
ds_read_b64_tr_b16 v[120:121], v163 offset:8192
ds_read_b64_tr_b16 v[122:123], v163 offset:8448
ds_read_b64_tr_b16 v[124:125], v164 offset:8192
ds_read_b64_tr_b16 v[126:127], v164 offset:8448
ds_read_b128 v[112:115], v165 offset:2048
s_waitcnt lgkmcnt(11)
v_mfma_f32_16x16x32_bf16 v[96:99], v[200:203], v[200:203], v[96:99]
v_mfma_f32_16x16x32_bf16 v[100:103], v[16:19], v[200:203], v[100:103]
s_waitcnt lgkmcnt(9)
v_mfma_f32_16x16x32_bf16 v[80:83], v[128:131], v[200:203], v[80:83]
v_mfma_f32_16x16x32_bf16 v[104:107], v[128:131], v[16:19], v[104:107]
s_add_u32 m0, s69, 24576
s_add_u32 s6, s15, 516096
buffer_load_dwordx4 v7, s[40:43], s6 offen lds
s_waitcnt lgkmcnt(7)
v_mfma_f32_16x16x32_bf16 v[84:87], v[132:135], v[200:203], v[84:87]
v_mfma_f32_16x16x32_bf16 v[108:111], v[132:135], v[16:19], v[108:111]
s_waitcnt lgkmcnt(6)
v_mfma_f32_16x16x32_bf16 v[88:91], v[128:131], v[116:119], v[88:91]
v_mfma_f32_16x16x32_bf16 v[92:95], v[132:135], v[116:119], v[92:95]
s_add_u32 m0, s14, 6144
s_add_u32 s4, s11, 384
buffer_load_dwordx4 v3, s[36:39], s4 offen lds
s_add_u32 m0, s14, 7168
s_add_u32 s4, s11, 384
buffer_load_dwordx4 v4, s[36:39], s4 offen lds
ds_read_b128 v[208:211], v6 offset:2048
ds_read_b64_tr_b16 v[128:129], v163 offset:12288
ds_read_b64_tr_b16 v[130:131], v163 offset:12544
ds_read_b64_tr_b16 v[132:133], v164 offset:12288
ds_read_b64_tr_b16 v[134:135], v164 offset:12544
ds_read_b128 v[116:119], v166 offset:2048
s_waitcnt lgkmcnt(11)
v_mfma_f32_16x16x32_bf16 v[96:99], v[204:207], v[204:207], v[96:99]
v_mfma_f32_16x16x32_bf16 v[100:103], v[16:19], v[204:207], v[100:103]
s_waitcnt lgkmcnt(9)
v_mfma_f32_16x16x32_bf16 v[80:83], v[120:123], v[204:207], v[80:83]
v_mfma_f32_16x16x32_bf16 v[104:107], v[120:123], v[16:19], v[104:107]
s_waitcnt lgkmcnt(7)
v_mfma_f32_16x16x32_bf16 v[84:87], v[124:127], v[204:207], v[84:87]
v_mfma_f32_16x16x32_bf16 v[108:111], v[124:127], v[16:19], v[108:111]
s_waitcnt lgkmcnt(6)
v_mfma_f32_16x16x32_bf16 v[88:91], v[120:123], v[112:115], v[88:91]
v_mfma_f32_16x16x32_bf16 v[92:95], v[124:127], v[112:115], v[92:95]
s_cmp_lg_u32 s32, 1
s_cbranch_scc1 L11
ds_read_b64 v[20:21], v167 offset:2048
ds_read_b64 v[22:23], v167 offset:34816
L11:
s_waitcnt vmcnt(3)
s_barrier
ds_read_b128 v[212:215], v5 offset:4096
ds_read_b64_tr_b16 v[120:121], v163 offset:16384
ds_read_b64_tr_b16 v[122:123], v163 offset:16640
ds_read_b64_tr_b16 v[124:125], v164 offset:16384
ds_read_b64_tr_b16 v[126:127], v164 offset:16640
ds_read_b128 v[112:115], v165 offset:4096
s_waitcnt lgkmcnt(11)
v_mfma_f32_16x16x32_bf16 v[96:99], v[208:211], v[208:211], v[96:99]
v_mfma_f32_16x16x32_bf16 v[100:103], v[16:19], v[208:211], v[100:103]
s_waitcnt lgkmcnt(9)
v_mfma_f32_16x16x32_bf16 v[80:83], v[128:131], v[208:211], v[80:83]
v_mfma_f32_16x16x32_bf16 v[104:107], v[128:131], v[16:19], v[104:107]
s_add_u32 m0, s69, 32768
s_add_u32 s6, s15, 688128
buffer_load_dwordx4 v7, s[40:43], s6 offen lds
s_waitcnt lgkmcnt(7)
v_mfma_f32_16x16x32_bf16 v[84:87], v[132:135], v[208:211], v[84:87]
v_mfma_f32_16x16x32_bf16 v[108:111], v[132:135], v[16:19], v[108:111]
s_waitcnt lgkmcnt(6)
v_mfma_f32_16x16x32_bf16 v[88:91], v[128:131], v[116:119], v[88:91]
v_mfma_f32_16x16x32_bf16 v[92:95], v[132:135], v[116:119], v[92:95]
s_add_u32 m0, s14, 0
s_add_u32 s4, s11, 512
buffer_load_dwordx4 v3, s[36:39], s4 offen lds
s_add_u32 m0, s14, 1024
s_add_u32 s4, s11, 512
buffer_load_dwordx4 v4, s[36:39], s4 offen lds
ds_read_b128 v[216:219], v6 offset:4096
ds_read_b64_tr_b16 v[128:129], v163 offset:20480
ds_read_b64_tr_b16 v[130:131], v163 offset:20736
ds_read_b64_tr_b16 v[132:133], v164 offset:20480
ds_read_b64_tr_b16 v[134:135], v164 offset:20736
ds_read_b128 v[116:119], v166 offset:4096
s_waitcnt lgkmcnt(11)
v_mfma_f32_16x16x32_bf16 v[96:99], v[212:215], v[212:215], v[96:99]
v_mfma_f32_16x16x32_bf16 v[100:103], v[16:19], v[212:215], v[100:103]
s_waitcnt lgkmcnt(9)
v_mfma_f32_16x16x32_bf16 v[80:83], v[120:123], v[212:215], v[80:83]
v_mfma_f32_16x16x32_bf16 v[104:107], v[120:123], v[16:19], v[104:107]
s_waitcnt lgkmcnt(7)
v_mfma_f32_16x16x32_bf16 v[84:87], v[124:127], v[212:215], v[84:87]
v_mfma_f32_16x16x32_bf16 v[108:111], v[124:127], v[16:19], v[108:111]
s_waitcnt lgkmcnt(6)
v_mfma_f32_16x16x32_bf16 v[88:91], v[120:123], v[112:115], v[88:91]
v_mfma_f32_16x16x32_bf16 v[92:95], v[124:127], v[112:115], v[92:95]
s_cmp_lg_u32 s32, 2
s_cbranch_scc1 L12
ds_read_b64 v[20:21], v167 offset:4096
ds_read_b64 v[22:23], v167 offset:36864
L12:
s_waitcnt vmcnt(3)
s_barrier
ds_read_b128 v[220:223], v5 offset:6144
ds_read_b64_tr_b16 v[120:121], v163 offset:24576
ds_read_b64_tr_b16 v[122:123], v163 offset:24832
ds_read_b64_tr_b16 v[124:125], v164 offset:24576
ds_read_b64_tr_b16 v[126:127], v164 offset:24832
ds_read_b128 v[112:115], v165 offset:6144
s_waitcnt lgkmcnt(11)
v_mfma_f32_16x16x32_bf16 v[96:99], v[216:219], v[216:219], v[96:99]
v_mfma_f32_16x16x32_bf16 v[100:103], v[16:19], v[216:219], v[100:103]
s_waitcnt lgkmcnt(9)
v_mfma_f32_16x16x32_bf16 v[80:83], v[128:131], v[216:219], v[80:83]
v_mfma_f32_16x16x32_bf16 v[104:107], v[128:131], v[16:19], v[104:107]
s_add_u32 m0, s69, 40960
s_add_u32 s6, s15, 860160
buffer_load_dwordx4 v7, s[40:43], s6 offen lds
s_waitcnt lgkmcnt(7)
v_mfma_f32_16x16x32_bf16 v[84:87], v[132:135], v[216:219], v[84:87]
v_mfma_f32_16x16x32_bf16 v[108:111], v[132:135], v[16:19], v[108:111]
s_waitcnt lgkmcnt(6)
v_mfma_f32_16x16x32_bf16 v[88:91], v[128:131], v[116:119], v[88:91]
v_mfma_f32_16x16x32_bf16 v[92:95], v[132:135], v[116:119], v[92:95]
s_add_u32 m0, s14, 2048
s_add_u32 s4, s11, 640
buffer_load_dwordx4 v3, s[36:39], s4 offen lds
s_add_u32 m0, s14, 3072
s_add_u32 s4, s11, 640
buffer_load_dwordx4 v4, s[36:39], s4 offen lds
ds_read_b128 v[224:227], v6 offset:6144
ds_read_b64_tr_b16 v[128:129], v163 offset:28672
ds_read_b64_tr_b16 v[130:131], v163 offset:28928
ds_read_b64_tr_b16 v[132:133], v164 offset:28672
ds_read_b64_tr_b16 v[134:135], v164 offset:28928
ds_read_b128 v[116:119], v166 offset:6144
s_waitcnt lgkmcnt(11)
v_mfma_f32_16x16x32_bf16 v[96:99], v[220:223], v[220:223], v[96:99]
v_mfma_f32_16x16x32_bf16 v[100:103], v[16:19], v[220:223], v[100:103]
s_waitcnt lgkmcnt(9)
v_mfma_f32_16x16x32_bf16 v[80:83], v[120:123], v[220:223], v[80:83]
v_mfma_f32_16x16x32_bf16 v[104:107], v[120:123], v[16:19], v[104:107]
s_waitcnt lgkmcnt(7)
v_mfma_f32_16x16x32_bf16 v[84:87], v[124:127], v[220:223], v[84:87]
v_mfma_f32_16x16x32_bf16 v[108:111], v[124:127], v[16:19], v[108:111]
s_waitcnt lgkmcnt(6)
v_mfma_f32_16x16x32_bf16 v[88:91], v[120:123], v[112:115], v[88:91]
v_mfma_f32_16x16x32_bf16 v[92:95], v[124:127], v[112:115], v[92:95]
s_cmp_lg_u32 s32, 3
s_cbranch_scc1 L13
ds_read_b64 v[20:21], v167 offset:6144
ds_read_b64 v[22:23], v167 offset:38912
L13:
s_waitcnt vmcnt(3)
s_barrier
ds_read_b128 v[228:231], v5 offset:0
ds_read_b64_tr_b16 v[120:121], v163 offset:32768
ds_read_b64_tr_b16 v[122:123], v163 offset:33024
ds_read_b64_tr_b16 v[124:125], v164 offset:32768
ds_read_b64_tr_b16 v[126:127], v164 offset:33024
ds_read_b128 v[112:115], v165 offset:0
s_waitcnt lgkmcnt(11)
v_mfma_f32_16x16x32_bf16 v[96:99], v[224:227], v[224:227], v[96:99]
v_mfma_f32_16x16x32_bf16 v[100:103], v[16:19], v[224:227], v[100:103]
s_waitcnt lgkmcnt(9)
v_mfma_f32_16x16x32_bf16 v[80:83], v[128:131], v[224:227], v[80:83]
v_mfma_f32_16x16x32_bf16 v[104:107], v[128:131], v[16:19], v[104:107]
s_add_u32 m0, s69, 49152
s_add_u32 s6, s15, 1032192
buffer_load_dwordx4 v7, s[40:43], s6 offen lds
s_waitcnt lgkmcnt(7)
v_mfma_f32_16x16x32_bf16 v[84:87], v[132:135], v[224:227], v[84:87]
v_mfma_f32_16x16x32_bf16 v[108:111], v[132:135], v[16:19], v[108:111]
s_waitcnt lgkmcnt(6)
v_mfma_f32_16x16x32_bf16 v[88:91], v[128:131], v[116:119], v[88:91]
v_mfma_f32_16x16x32_bf16 v[92:95], v[132:135], v[116:119], v[92:95]
s_add_u32 m0, s14, 4096
s_add_u32 s4, s11, 768
buffer_load_dwordx4 v3, s[36:39], s4 offen lds
s_add_u32 m0, s14, 5120
s_add_u32 s4, s11, 768
buffer_load_dwordx4 v4, s[36:39], s4 offen lds
ds_read_b128 v[232:235], v6 offset:0
ds_read_b64_tr_b16 v[128:129], v163 offset:36864
ds_read_b64_tr_b16 v[130:131], v163 offset:37120
ds_read_b64_tr_b16 v[132:133], v164 offset:36864
ds_read_b64_tr_b16 v[134:135], v164 offset:37120
ds_read_b128 v[116:119], v166 offset:0
s_waitcnt lgkmcnt(11)
v_mfma_f32_16x16x32_bf16 v[96:99], v[228:231], v[228:231], v[96:99]
v_mfma_f32_16x16x32_bf16 v[100:103], v[16:19], v[228:231], v[100:103]
s_waitcnt lgkmcnt(9)
v_mfma_f32_16x16x32_bf16 v[80:83], v[120:123], v[228:231], v[80:83]
v_mfma_f32_16x16x32_bf16 v[104:107], v[120:123], v[16:19], v[104:107]
s_waitcnt lgkmcnt(7)
v_mfma_f32_16x16x32_bf16 v[84:87], v[124:127], v[228:231], v[84:87]
v_mfma_f32_16x16x32_bf16 v[108:111], v[124:127], v[16:19], v[108:111]
s_waitcnt lgkmcnt(6)
v_mfma_f32_16x16x32_bf16 v[88:91], v[120:123], v[112:115], v[88:91]
v_mfma_f32_16x16x32_bf16 v[92:95], v[124:127], v[112:115], v[92:95]
s_cmp_lg_u32 s32, 4
s_cbranch_scc1 L14
ds_read_b64 v[20:21], v167 offset:0
ds_read_b64 v[22:23], v167 offset:32768
L14:
s_waitcnt vmcnt(3)
s_barrier
ds_read_b128 v[236:239], v5 offset:2048
ds_read_b64_tr_b16 v[120:121], v163 offset:40960
ds_read_b64_tr_b16 v[122:123], v163 offset:41216
ds_read_b64_tr_b16 v[124:125], v164 offset:40960
ds_read_b64_tr_b16 v[126:127], v164 offset:41216
ds_read_b128 v[112:115], v165 offset:2048
s_waitcnt lgkmcnt(11)
v_mfma_f32_16x16x32_bf16 v[96:99], v[232:235], v[232:235], v[96:99]
v_mfma_f32_16x16x32_bf16 v[100:103], v[16:19], v[232:235], v[100:103]
s_waitcnt lgkmcnt(9)
v_mfma_f32_16x16x32_bf16 v[80:83], v[128:131], v[232:235], v[80:83]
v_mfma_f32_16x16x32_bf16 v[104:107], v[128:131], v[16:19], v[104:107]
s_waitcnt lgkmcnt(7)
v_mfma_f32_16x16x32_bf16 v[84:87], v[132:135], v[232:235], v[84:87]
v_mfma_f32_16x16x32_bf16 v[108:111], v[132:135], v[16:19], v[108:111]
s_waitcnt lgkmcnt(6)
v_mfma_f32_16x16x32_bf16 v[88:91], v[128:131], v[116:119], v[88:91]
v_mfma_f32_16x16x32_bf16 v[92:95], v[132:135], v[116:119], v[92:95]
ds_read_b64 v[24:25], v11 offset:24
s_add_u32 s4, s64, 0
s_mul_i32 s6, s4, 43008
s_lshl_b32 s4, s4, 10
s_add_u32 m0, s4, 57344
s_add_u32 s6, s6, s68
buffer_load_dwordx4 v7, s[40:43], s6 offen lds
s_add_u32 s4, s64, 8
s_mul_i32 s6, s4, 43008
s_lshl_b32 s4, s4, 10
s_add_u32 m0, s4, 57344
s_add_u32 s6, s6, s68
buffer_load_dwordx4 v7, s[40:43], s6 offen lds
ds_read_b128 v[240:243], v6 offset:2048
ds_read_b64_tr_b16 v[128:129], v163 offset:45056
ds_read_b64_tr_b16 v[130:131], v163 offset:45312
ds_read_b64_tr_b16 v[132:133], v164 offset:45056
ds_read_b64_tr_b16 v[134:135], v164 offset:45312
ds_read_b128 v[116:119], v166 offset:2048
s_waitcnt lgkmcnt(12)
v_mfma_f32_16x16x32_bf16 v[96:99], v[236:239], v[236:239], v[96:99]
v_mfma_f32_16x16x32_bf16 v[100:103], v[16:19], v[236:239], v[100:103]
s_waitcnt lgkmcnt(10)
v_mfma_f32_16x16x32_bf16 v[80:83], v[120:123], v[236:239], v[80:83]
v_mfma_f32_16x16x32_bf16 v[104:107], v[120:123], v[16:19], v[104:107]
s_waitcnt lgkmcnt(8)
v_mfma_f32_16x16x32_bf16 v[84:87], v[124:127], v[236:239], v[84:87]
v_mfma_f32_16x16x32_bf16 v[108:111], v[124:127], v[16:19], v[108:111]
s_waitcnt lgkmcnt(7)
v_mfma_f32_16x16x32_bf16 v[88:91], v[120:123], v[112:115], v[88:91]
v_mfma_f32_16x16x32_bf16 v[92:95], v[124:127], v[112:115], v[92:95]
s_cmp_lg_u32 s32, 5
s_cbranch_scc1 L15
ds_read_b64 v[20:21], v167 offset:2048
ds_read_b64 v[22:23], v167 offset:34816
L15:
s_add_u32 s4, s64, 16
s_mul_i32 s6, s4, 43008
s_lshl_b32 s4, s4, 10
s_add_u32 m0, s4, 57344
s_add_u32 s6, s6, s68
buffer_load_dwordx4 v7, s[40:43], s6 offen lds
s_add_u32 s4, s64, 24
s_min_u32 s4, s4, 27
s_mul_i32 s6, s4, 43008
s_lshl_b32 s4, s4, 10
s_add_u32 m0, s4, 57344
s_add_u32 s6, s6, s68
buffer_load_dwordx4 v7, s[40:43], s6 offen lds
s_waitcnt vmcnt(4)
s_barrier
ds_read_b128 v[244:247], v5 offset:4096
ds_read_b64_tr_b16 v[120:121], v163 offset:49152
ds_read_b64_tr_b16 v[122:123], v163 offset:49408
ds_read_b64_tr_b16 v[124:125], v164 offset:49152
ds_read_b64_tr_b16 v[126:127], v164 offset:49408
ds_read_b128 v[112:115], v165 offset:4096
s_waitcnt lgkmcnt(11)
v_mfma_f32_16x16x32_bf16 v[96:99], v[240:243], v[240:243], v[96:99]
v_mfma_f32_16x16x32_bf16 v[100:103], v[16:19], v[240:243], v[100:103]
s_waitcnt lgkmcnt(9)
v_mfma_f32_16x16x32_bf16 v[80:83], v[128:131], v[240:243], v[80:83]
v_mfma_f32_16x16x32_bf16 v[104:107], v[128:131], v[16:19], v[104:107]
s_waitcnt lgkmcnt(7)
v_mfma_f32_16x16x32_bf16 v[84:87], v[132:135], v[240:243], v[84:87]
v_mfma_f32_16x16x32_bf16 v[108:111], v[132:135], v[16:19], v[108:111]
s_waitcnt lgkmcnt(6)
v_mfma_f32_16x16x32_bf16 v[88:91], v[128:131], v[116:119], v[88:91]
v_mfma_f32_16x16x32_bf16 v[92:95], v[132:135], v[116:119], v[92:95]
ds_read_b128 v[248:251], v6 offset:4096
ds_read_b64_tr_b16 v[128:129], v163 offset:53248
ds_read_b64_tr_b16 v[130:131], v163 offset:53504
ds_read_b64_tr_b16 v[132:133], v164 offset:53248
ds_read_b64_tr_b16 v[134:135], v164 offset:53504
ds_read_b128 v[116:119], v166 offset:4096
s_waitcnt lgkmcnt(11)
v_mfma_f32_16x16x32_bf16 v[96:99], v[244:247], v[244:247], v[96:99]
v_mfma_f32_16x16x32_bf16 v[100:103], v[16:19], v[244:247], v[100:103]
s_waitcnt lgkmcnt(9)
v_mfma_f32_16x16x32_bf16 v[80:83], v[120:123], v[244:247], v[80:83]
v_mfma_f32_16x16x32_bf16 v[104:107], v[120:123], v[16:19], v[104:107]
s_waitcnt lgkmcnt(7)
v_mfma_f32_16x16x32_bf16 v[84:87], v[124:127], v[244:247], v[84:87]
v_mfma_f32_16x16x32_bf16 v[108:111], v[124:127], v[16:19], v[108:111]
s_waitcnt lgkmcnt(6)
v_mfma_f32_16x16x32_bf16 v[88:91], v[120:123], v[112:115], v[88:91]
v_mfma_f32_16x16x32_bf16 v[92:95], v[124:127], v[112:115], v[92:95]
s_cmp_lg_u32 s32, 6
s_cbranch_scc1 L16
ds_read_b64 v[20:21], v167 offset:4096
ds_read_b64 v[22:23], v167 offset:36864
L16:
s_waitcnt lgkmcnt(5)
v_mfma_f32_16x16x32_bf16 v[96:99], v[248:251], v[248:251], v[96:99]
v_mfma_f32_16x16x32_bf16 v[100:103], v[16:19], v[248:251], v[100:103]
s_waitcnt lgkmcnt(3)
v_mfma_f32_16x16x32_bf16 v[80:83], v[128:131], v[248:251], v[80:83]
v_mfma_f32_16x16x32_bf16 v[104:107], v[128:131], v[16:19], v[104:107]
s_waitcnt lgkmcnt(1)
v_mfma_f32_16x16x32_bf16 v[84:87], v[132:135], v[248:251], v[84:87]
v_mfma_f32_16x16x32_bf16 v[108:111], v[132:135], v[16:19], v[108:111]
s_waitcnt lgkmcnt(0)
v_mfma_f32_16x16x32_bf16 v[88:91], v[128:131], v[116:119], v[88:91]
v_mfma_f32_16x16x32_bf16 v[92:95], v[132:135], v[116:119], v[92:95]
v_cndmask_b32 v4, v96, v97, s[76:77]
v_cndmask_b32 v4, v4, v98, s[78:79]
v_cndmask_b32 v4, v4, v99, s[80:81]
v_mul_f32 v5, 0x3b124925, v100
v_mul_f32 v6, 0x3b124925, v4
v_fma_f32 v6, -v5, v5, v6
v_max_f32 v6, 0, v6
v_add_f32 v6, 0x3727c5ac, v6
v_rsq_f32 v32, v6
s_lshl_b32 s4, s64, 7
s_add_u32 s4, s4, 157696
v_mul_f32_e64 v33, -v5, v32
v_lshl_add_u32 v3, v15, 3, s4
s_mov_b64 exec, s[82:83]
ds_write_b64 v3, v[32:33]
s_mov_b64 exec, -1
s_and_b32 s5, s64, 6
s_lshl_b32 s6, s5, 7
s_add_u32 s6, s6, 157696
s_lshl_b32 s11, s67, 14
s_lshl_b32 s5, s5, 10
s_add_u32 s11, s11, s5
s_add_u32 s11, s11, 0x800000
v_add_u32 v6, s5, v1
v_lshl_add_u32 v4, v15, 3, s6
s_waitcnt lgkmcnt(0)
s_barrier
ds_read_b64 v[148:149], v3
ds_read_b64 v[150:151], v4 offset:128
s_waitcnt lgkmcnt(0)
v_mul_f32 v3, v104, v149
v_fma_f32 v80, v80, v148, v3
v_mul_f32 v3, v105, v149
v_fma_f32 v81, v81, v148, v3
v_mul_f32 v3, v106, v149
v_fma_f32 v82, v82, v148, v3
v_mul_f32 v3, v107, v149
v_fma_f32 v83, v83, v148, v3
v_cvt_pk_bf16_f32 v140, v80, v81
v_cvt_pk_bf16_f32 v141, v82, v83
v_mul_f32 v3, v108, v149
v_fma_f32 v84, v84, v148, v3
v_mul_f32 v3, v109, v149
v_fma_f32 v85, v85, v148, v3
v_mul_f32 v3, v110, v149
v_fma_f32 v86, v86, v148, v3
v_mul_f32 v3, v111, v149
v_fma_f32 v87, v87, v148, v3
v_cvt_pk_bf16_f32 v142, v84, v85
v_cvt_pk_bf16_f32 v143, v86, v87
s_mov_b32 exec_lo, 0x0
s_mov_b32 exec_hi, 0xffff0000
v_mov_b32 v142, 0
v_mov_b32 v143, 0
s_mov_b64 exec, -1
buffer_store_dwordx4 v[140:143], v1, s[52:55], s11 offen offset:0 sc1
v_mul_f32 v3, v104, v151
v_fma_f32 v88, v88, v150, v3
v_mul_f32 v3, v105, v151
v_fma_f32 v89, v89, v150, v3
v_mul_f32 v3, v106, v151
v_fma_f32 v90, v90, v150, v3
v_mul_f32 v3, v107, v151
v_fma_f32 v91, v91, v150, v3
v_cvt_pk_bf16_f32 v144, v88, v89
v_cvt_pk_bf16_f32 v145, v90, v91
v_mul_f32 v3, v108, v151
v_fma_f32 v92, v92, v150, v3
v_mul_f32 v3, v109, v151
v_fma_f32 v93, v93, v150, v3
v_mul_f32 v3, v110, v151
v_fma_f32 v94, v94, v150, v3
v_mul_f32 v3, v111, v151
v_fma_f32 v95, v95, v150, v3
v_cvt_pk_bf16_f32 v146, v92, v93
v_cvt_pk_bf16_f32 v147, v94, v95
s_mov_b32 exec_lo, 0x0
s_mov_b32 exec_hi, 0xffff0000
v_mov_b32 v146, 0
v_mov_b32 v147, 0
s_mov_b64 exec, -1
buffer_store_dwordx4 v[144:147], v1, s[52:55], s11 offen offset:1024 sc1
ds_write_b128 v6, v[140:143] offset:16384
ds_write_b128 v6, v[144:147] offset:17408
s_branch L9
L8:
s_waitcnt vmcnt(3)
s_barrier
ds_read_b128 v[196:199], v5 offset:0
ds_read_b64_tr_b16 v[120:121], v163 offset:0
ds_read_b64_tr_b16 v[122:123], v163 offset:256
ds_read_b64_tr_b16 v[124:125], v164 offset:0
ds_read_b64_tr_b16 v[126:127], v164 offset:256
ds_read_b128 v[112:115], v165 offset:0
ds_read_b128 v[200:203], v6 offset:0
ds_read_b64_tr_b16 v[128:129], v163 offset:4096
ds_read_b64_tr_b16 v[130:131], v163 offset:4352
ds_read_b64_tr_b16 v[132:133], v164 offset:4096
ds_read_b64_tr_b16 v[134:135], v164 offset:4352
ds_read_b128 v[116:119], v166 offset:0
s_waitcnt lgkmcnt(11)
v_mfma_f32_16x16x32_bf16 v[96:99], v[196:199], v[196:199], 0
v_mfma_f32_16x16x32_bf16 v[100:103], v[16:19], v[196:199], 0
s_waitcnt lgkmcnt(9)
v_mfma_f32_16x16x32_bf16 v[80:83], v[196:199], v[120:123], 0
v_mfma_f32_16x16x32_bf16 v[104:107], v[16:19], v[120:123], 0
s_add_u32 m0, s69, 16384
s_add_u32 s6, s15, 344064
buffer_load_dwordx4 v7, s[40:43], s6 offen lds
s_waitcnt lgkmcnt(7)
v_mfma_f32_16x16x32_bf16 v[84:87], v[196:199], v[124:127], 0
v_mfma_f32_16x16x32_bf16 v[108:111], v[16:19], v[124:127], 0
s_waitcnt lgkmcnt(6)
v_mfma_f32_16x16x32_bf16 v[88:91], v[112:115], v[120:123], 0
v_mfma_f32_16x16x32_bf16 v[92:95], v[112:115], v[124:127], 0
s_add_u32 m0, s14, 4096
s_add_u32 s4, s11, 256
buffer_load_dwordx4 v3, s[36:39], s4 offen lds
s_add_u32 m0, s14, 5120
s_add_u32 s4, s11, 256
buffer_load_dwordx4 v4, s[36:39], s4 offen lds
s_cmp_lg_u32 s32, 0
s_cbranch_scc1 L17
ds_read_b64 v[20:21], v167 offset:0
ds_read_b64 v[22:23], v167 offset:32768
L17:
s_waitcnt vmcnt(3)
s_barrier
ds_read_b128 v[204:207], v5 offset:2048
ds_read_b64_tr_b16 v[120:121], v163 offset:8192
ds_read_b64_tr_b16 v[122:123], v163 offset:8448
ds_read_b64_tr_b16 v[124:125], v164 offset:8192
ds_read_b64_tr_b16 v[126:127], v164 offset:8448
ds_read_b128 v[112:115], v165 offset:2048
s_waitcnt lgkmcnt(11)
v_mfma_f32_16x16x32_bf16 v[96:99], v[200:203], v[200:203], v[96:99]
v_mfma_f32_16x16x32_bf16 v[100:103], v[16:19], v[200:203], v[100:103]
s_waitcnt lgkmcnt(9)
v_mfma_f32_16x16x32_bf16 v[80:83], v[200:203], v[128:131], v[80:83]
v_mfma_f32_16x16x32_bf16 v[104:107], v[16:19], v[128:131], v[104:107]
s_add_u32 m0, s69, 24576
s_add_u32 s6, s15, 516096
buffer_load_dwordx4 v7, s[40:43], s6 offen lds
s_waitcnt lgkmcnt(7)
v_mfma_f32_16x16x32_bf16 v[84:87], v[200:203], v[132:135], v[84:87]
v_mfma_f32_16x16x32_bf16 v[108:111], v[16:19], v[132:135], v[108:111]
s_waitcnt lgkmcnt(6)
v_mfma_f32_16x16x32_bf16 v[88:91], v[116:119], v[128:131], v[88:91]
v_mfma_f32_16x16x32_bf16 v[92:95], v[116:119], v[132:135], v[92:95]
s_add_u32 m0, s14, 6144
s_add_u32 s4, s11, 384
buffer_load_dwordx4 v3, s[36:39], s4 offen lds
s_add_u32 m0, s14, 7168
s_add_u32 s4, s11, 384
buffer_load_dwordx4 v4, s[36:39], s4 offen lds
ds_read_b128 v[208:211], v6 offset:2048
ds_read_b64_tr_b16 v[128:129], v163 offset:12288
ds_read_b64_tr_b16 v[130:131], v163 offset:12544
ds_read_b64_tr_b16 v[132:133], v164 offset:12288
ds_read_b64_tr_b16 v[134:135], v164 offset:12544
ds_read_b128 v[116:119], v166 offset:2048
s_waitcnt lgkmcnt(11)
v_mfma_f32_16x16x32_bf16 v[96:99], v[204:207], v[204:207], v[96:99]
v_mfma_f32_16x16x32_bf16 v[100:103], v[16:19], v[204:207], v[100:103]
s_waitcnt lgkmcnt(9)
v_mfma_f32_16x16x32_bf16 v[80:83], v[204:207], v[120:123], v[80:83]
v_mfma_f32_16x16x32_bf16 v[104:107], v[16:19], v[120:123], v[104:107]
s_waitcnt lgkmcnt(7)
v_mfma_f32_16x16x32_bf16 v[84:87], v[204:207], v[124:127], v[84:87]
v_mfma_f32_16x16x32_bf16 v[108:111], v[16:19], v[124:127], v[108:111]
s_waitcnt lgkmcnt(6)
v_mfma_f32_16x16x32_bf16 v[88:91], v[112:115], v[120:123], v[88:91]
v_mfma_f32_16x16x32_bf16 v[92:95], v[112:115], v[124:127], v[92:95]
s_cmp_lg_u32 s32, 1
s_cbranch_scc1 L18
ds_read_b64 v[20:21], v167 offset:2048
ds_read_b64 v[22:23], v167 offset:34816
L18:
s_waitcnt vmcnt(3)
s_barrier
ds_read_b128 v[212:215], v5 offset:4096
ds_read_b64_tr_b16 v[120:121], v163 offset:16384
ds_read_b64_tr_b16 v[122:123], v163 offset:16640
ds_read_b64_tr_b16 v[124:125], v164 offset:16384
ds_read_b64_tr_b16 v[126:127], v164 offset:16640
ds_read_b128 v[112:115], v165 offset:4096
s_waitcnt lgkmcnt(11)
v_mfma_f32_16x16x32_bf16 v[96:99], v[208:211], v[208:211], v[96:99]
v_mfma_f32_16x16x32_bf16 v[100:103], v[16:19], v[208:211], v[100:103]
s_waitcnt lgkmcnt(9)
v_mfma_f32_16x16x32_bf16 v[80:83], v[208:211], v[128:131], v[80:83]
v_mfma_f32_16x16x32_bf16 v[104:107], v[16:19], v[128:131], v[104:107]
s_add_u32 m0, s69, 32768
s_add_u32 s6, s15, 688128
buffer_load_dwordx4 v7, s[40:43], s6 offen lds
s_waitcnt lgkmcnt(7)
v_mfma_f32_16x16x32_bf16 v[84:87], v[208:211], v[132:135], v[84:87]
v_mfma_f32_16x16x32_bf16 v[108:111], v[16:19], v[132:135], v[108:111]
s_waitcnt lgkmcnt(6)
v_mfma_f32_16x16x32_bf16 v[88:91], v[116:119], v[128:131], v[88:91]
v_mfma_f32_16x16x32_bf16 v[92:95], v[116:119], v[132:135], v[92:95]
s_add_u32 m0, s14, 0
s_add_u32 s4, s11, 512
buffer_load_dwordx4 v3, s[36:39], s4 offen lds
s_add_u32 m0, s14, 1024
s_add_u32 s4, s11, 512
buffer_load_dwordx4 v4, s[36:39], s4 offen lds
ds_read_b128 v[216:219], v6 offset:4096
ds_read_b64_tr_b16 v[128:129], v163 offset:20480
ds_read_b64_tr_b16 v[130:131], v163 offset:20736
ds_read_b64_tr_b16 v[132:133], v164 offset:20480
ds_read_b64_tr_b16 v[134:135], v164 offset:20736
ds_read_b128 v[116:119], v166 offset:4096
s_waitcnt lgkmcnt(11)
v_mfma_f32_16x16x32_bf16 v[96:99], v[212:215], v[212:215], v[96:99]
v_mfma_f32_16x16x32_bf16 v[100:103], v[16:19], v[212:215], v[100:103]
s_waitcnt lgkmcnt(9)
v_mfma_f32_16x16x32_bf16 v[80:83], v[212:215], v[120:123], v[80:83]
v_mfma_f32_16x16x32_bf16 v[104:107], v[16:19], v[120:123], v[104:107]
s_waitcnt lgkmcnt(7)
v_mfma_f32_16x16x32_bf16 v[84:87], v[212:215], v[124:127], v[84:87]
v_mfma_f32_16x16x32_bf16 v[108:111], v[16:19], v[124:127], v[108:111]
s_waitcnt lgkmcnt(6)
v_mfma_f32_16x16x32_bf16 v[88:91], v[112:115], v[120:123], v[88:91]
v_mfma_f32_16x16x32_bf16 v[92:95], v[112:115], v[124:127], v[92:95]
s_cmp_lg_u32 s32, 2
s_cbranch_scc1 L19
ds_read_b64 v[20:21], v167 offset:4096
ds_read_b64 v[22:23], v167 offset:36864
L19:
s_cmp_lg_u32 s64, 7
s_cbranch_scc1 L20
s_mov_b32 s10, 0
v_cmp_ne_u32 vcc, 0, v25
s_cbranch_vccnz L22
L21:
buffer_load_dwordx2 v[24:25], v12, s[48:51], 0 offen sc1
s_add_u32 s10, s10, 1
s_cmp_gt_u32 s10, 0x40000
s_waitcnt vmcnt(0)
s_cbranch_scc1 L22
v_cmp_eq_u32 vcc, 0, v25
s_cbranch_vccnz L21
L22:
ds_write_b64 v11, v[24:25] offset:24
v_or_b32 v26, s100, v24
v_mov_b32 v27, v25
s_lshl_b32 s4, s67, 3
s_add_u32 s4, s4, 0x21000
s_mov_b64 exec, 1
buffer_store_dwordx2 v[26:27], v1, s[52:55], s4 offen sc1
s_lshl_b32 s4, s33, 3
s_add_u32 s4, s4, 0x21800
buffer_store_dwordx2 v[26:27], v1, s[52:55], s4 offen sc1
s_mov_b64 exec, -1
s_waitcnt lgkmcnt(0)
L20:
s_waitcnt vmcnt(3)
s_barrier
ds_read_b128 v[220:223], v5 offset:6144
ds_read_b64_tr_b16 v[120:121], v163 offset:24576
ds_read_b64_tr_b16 v[122:123], v163 offset:24832
ds_read_b64_tr_b16 v[124:125], v164 offset:24576
ds_read_b64_tr_b16 v[126:127], v164 offset:24832
ds_read_b128 v[112:115], v165 offset:6144
s_waitcnt lgkmcnt(11)
v_mfma_f32_16x16x32_bf16 v[96:99], v[216:219], v[216:219], v[96:99]
v_mfma_f32_16x16x32_bf16 v[100:103], v[16:19], v[216:219], v[100:103]
s_waitcnt lgkmcnt(9)
v_mfma_f32_16x16x32_bf16 v[80:83], v[216:219], v[128:131], v[80:83]
v_mfma_f32_16x16x32_bf16 v[104:107], v[16:19], v[128:131], v[104:107]
s_add_u32 m0, s69, 40960
s_add_u32 s6, s15, 860160
buffer_load_dwordx4 v7, s[40:43], s6 offen lds
s_waitcnt lgkmcnt(7)
v_mfma_f32_16x16x32_bf16 v[84:87], v[216:219], v[132:135], v[84:87]
v_mfma_f32_16x16x32_bf16 v[108:111], v[16:19], v[132:135], v[108:111]
s_waitcnt lgkmcnt(6)
v_mfma_f32_16x16x32_bf16 v[88:91], v[116:119], v[128:131], v[88:91]
v_mfma_f32_16x16x32_bf16 v[92:95], v[116:119], v[132:135], v[92:95]
s_add_u32 m0, s14, 2048
s_add_u32 s4, s11, 640
buffer_load_dwordx4 v3, s[36:39], s4 offen lds
s_add_u32 m0, s14, 3072
s_add_u32 s4, s11, 640
buffer_load_dwordx4 v4, s[36:39], s4 offen lds
ds_read_b128 v[224:227], v6 offset:6144
ds_read_b64_tr_b16 v[128:129], v163 offset:28672
ds_read_b64_tr_b16 v[130:131], v163 offset:28928
ds_read_b64_tr_b16 v[132:133], v164 offset:28672
ds_read_b64_tr_b16 v[134:135], v164 offset:28928
ds_read_b128 v[116:119], v166 offset:6144
s_waitcnt lgkmcnt(11)
v_mfma_f32_16x16x32_bf16 v[96:99], v[220:223], v[220:223], v[96:99]
v_mfma_f32_16x16x32_bf16 v[100:103], v[16:19], v[220:223], v[100:103]
s_waitcnt lgkmcnt(9)
v_mfma_f32_16x16x32_bf16 v[80:83], v[220:223], v[120:123], v[80:83]
v_mfma_f32_16x16x32_bf16 v[104:107], v[16:19], v[120:123], v[104:107]
s_waitcnt lgkmcnt(7)
v_mfma_f32_16x16x32_bf16 v[84:87], v[220:223], v[124:127], v[84:87]
v_mfma_f32_16x16x32_bf16 v[108:111], v[16:19], v[124:127], v[108:111]
s_waitcnt lgkmcnt(6)
v_mfma_f32_16x16x32_bf16 v[88:91], v[112:115], v[120:123], v[88:91]
v_mfma_f32_16x16x32_bf16 v[92:95], v[112:115], v[124:127], v[92:95]
s_cmp_lg_u32 s32, 3
s_cbranch_scc1 L23
ds_read_b64 v[20:21], v167 offset:6144
ds_read_b64 v[22:23], v167 offset:38912
L23:
s_waitcnt vmcnt(3)
s_barrier
ds_read_b128 v[228:231], v5 offset:0
ds_read_b64_tr_b16 v[120:121], v163 offset:32768
ds_read_b64_tr_b16 v[122:123], v163 offset:33024
ds_read_b64_tr_b16 v[124:125], v164 offset:32768
ds_read_b64_tr_b16 v[126:127], v164 offset:33024
ds_read_b128 v[112:115], v165 offset:0
s_waitcnt lgkmcnt(11)
v_mfma_f32_16x16x32_bf16 v[96:99], v[224:227], v[224:227], v[96:99]
v_mfma_f32_16x16x32_bf16 v[100:103], v[16:19], v[224:227], v[100:103]
s_waitcnt lgkmcnt(9)
v_mfma_f32_16x16x32_bf16 v[80:83], v[224:227], v[128:131], v[80:83]
v_mfma_f32_16x16x32_bf16 v[104:107], v[16:19], v[128:131], v[104:107]
s_add_u32 m0, s69, 49152
s_add_u32 s6, s15, 1032192
buffer_load_dwordx4 v7, s[40:43], s6 offen lds
s_waitcnt lgkmcnt(7)
v_mfma_f32_16x16x32_bf16 v[84:87], v[224:227], v[132:135], v[84:87]
v_mfma_f32_16x16x32_bf16 v[108:111], v[16:19], v[132:135], v[108:111]
s_waitcnt lgkmcnt(6)
v_mfma_f32_16x16x32_bf16 v[88:91], v[116:119], v[128:131], v[88:91]
v_mfma_f32_16x16x32_bf16 v[92:95], v[116:119], v[132:135], v[92:95]
s_add_u32 m0, s14, 4096
s_add_u32 s4, s11, 768
buffer_load_dwordx4 v3, s[36:39], s4 offen lds
s_add_u32 m0, s14, 5120
s_add_u32 s4, s11, 768
buffer_load_dwordx4 v4, s[36:39], s4 offen lds
ds_read_b128 v[232:235], v6 offset:0
ds_read_b64_tr_b16 v[128:129], v163 offset:36864
ds_read_b64_tr_b16 v[130:131], v163 offset:37120
ds_read_b64_tr_b16 v[132:133], v164 offset:36864
ds_read_b64_tr_b16 v[134:135], v164 offset:37120
ds_read_b128 v[116:119], v166 offset:0
s_waitcnt lgkmcnt(11)
v_mfma_f32_16x16x32_bf16 v[96:99], v[228:231], v[228:231], v[96:99]
v_mfma_f32_16x16x32_bf16 v[100:103], v[16:19], v[228:231], v[100:103]
s_waitcnt lgkmcnt(9)
v_mfma_f32_16x16x32_bf16 v[80:83], v[228:231], v[120:123], v[80:83]
v_mfma_f32_16x16x32_bf16 v[104:107], v[16:19], v[120:123], v[104:107]
s_waitcnt lgkmcnt(7)
v_mfma_f32_16x16x32_bf16 v[84:87], v[228:231], v[124:127], v[84:87]
v_mfma_f32_16x16x32_bf16 v[108:111], v[16:19], v[124:127], v[108:111]
s_waitcnt lgkmcnt(6)
v_mfma_f32_16x16x32_bf16 v[88:91], v[112:115], v[120:123], v[88:91]
v_mfma_f32_16x16x32_bf16 v[92:95], v[112:115], v[124:127], v[92:95]
s_cmp_lg_u32 s32, 4
s_cbranch_scc1 L24
ds_read_b64 v[20:21], v167 offset:0
ds_read_b64 v[22:23], v167 offset:32768
L24:
s_waitcnt vmcnt(3)
s_barrier
ds_read_b128 v[236:239], v5 offset:2048
ds_read_b64_tr_b16 v[120:121], v163 offset:40960
ds_read_b64_tr_b16 v[122:123], v163 offset:41216
ds_read_b64_tr_b16 v[124:125], v164 offset:40960
ds_read_b64_tr_b16 v[126:127], v164 offset:41216
ds_read_b128 v[112:115], v165 offset:2048
s_waitcnt lgkmcnt(11)
v_mfma_f32_16x16x32_bf16 v[96:99], v[232:235], v[232:235], v[96:99]
v_mfma_f32_16x16x32_bf16 v[100:103], v[16:19], v[232:235], v[100:103]
s_waitcnt lgkmcnt(9)
v_mfma_f32_16x16x32_bf16 v[80:83], v[232:235], v[128:131], v[80:83]
v_mfma_f32_16x16x32_bf16 v[104:107], v[16:19], v[128:131], v[104:107]
s_waitcnt lgkmcnt(7)
v_mfma_f32_16x16x32_bf16 v[84:87], v[232:235], v[132:135], v[84:87]
v_mfma_f32_16x16x32_bf16 v[108:111], v[16:19], v[132:135], v[108:111]
s_waitcnt lgkmcnt(6)
v_mfma_f32_16x16x32_bf16 v[88:91], v[116:119], v[128:131], v[88:91]
v_mfma_f32_16x16x32_bf16 v[92:95], v[116:119], v[132:135], v[92:95]
ds_read_b64 v[24:25], v11 offset:24
s_add_u32 s4, s64, 0
s_mul_i32 s6, s4, 43008
s_lshl_b32 s4, s4, 10
s_add_u32 m0, s4, 57344
s_add_u32 s6, s6, s68
buffer_load_dwordx4 v7, s[40:43], s6 offen lds
s_add_u32 s4, s64, 8
s_mul_i32 s6, s4, 43008
s_lshl_b32 s4, s4, 10
s_add_u32 m0, s4, 57344
s_add_u32 s6, s6, s68
buffer_load_dwordx4 v7, s[40:43], s6 offen lds
ds_read_b128 v[240:243], v6 offset:2048
ds_read_b64_tr_b16 v[128:129], v163 offset:45056
ds_read_b64_tr_b16 v[130:131], v163 offset:45312
ds_read_b64_tr_b16 v[132:133], v164 offset:45056
ds_read_b64_tr_b16 v[134:135], v164 offset:45312
ds_read_b128 v[116:119], v166 offset:2048
s_waitcnt lgkmcnt(12)
v_mfma_f32_16x16x32_bf16 v[96:99], v[236:239], v[236:239], v[96:99]
v_mfma_f32_16x16x32_bf16 v[100:103], v[16:19], v[236:239], v[100:103]
s_waitcnt lgkmcnt(10)
v_mfma_f32_16x16x32_bf16 v[80:83], v[236:239], v[120:123], v[80:83]
v_mfma_f32_16x16x32_bf16 v[104:107], v[16:19], v[120:123], v[104:107]
s_waitcnt lgkmcnt(8)
v_mfma_f32_16x16x32_bf16 v[84:87], v[236:239], v[124:127], v[84:87]
v_mfma_f32_16x16x32_bf16 v[108:111], v[16:19], v[124:127], v[108:111]
s_waitcnt lgkmcnt(7)
v_mfma_f32_16x16x32_bf16 v[88:91], v[112:115], v[120:123], v[88:91]
v_mfma_f32_16x16x32_bf16 v[92:95], v[112:115], v[124:127], v[92:95]
s_cmp_lg_u32 s32, 5
s_cbranch_scc1 L25
ds_read_b64 v[20:21], v167 offset:2048
ds_read_b64 v[22:23], v167 offset:34816
L25:
s_add_u32 s4, s64, 16
s_mul_i32 s6, s4, 43008
s_lshl_b32 s4, s4, 10
s_add_u32 m0, s4, 57344
s_add_u32 s6, s6, s68
buffer_load_dwordx4 v7, s[40:43], s6 offen lds
s_add_u32 s4, s64, 24
s_min_u32 s4, s4, 27
s_mul_i32 s6, s4, 43008
s_lshl_b32 s4, s4, 10
s_add_u32 m0, s4, 57344
s_add_u32 s6, s6, s68
buffer_load_dwordx4 v7, s[40:43], s6 offen lds
s_waitcnt vmcnt(4)
s_barrier
ds_read_b128 v[244:247], v5 offset:4096
ds_read_b64_tr_b16 v[120:121], v163 offset:49152
ds_read_b64_tr_b16 v[122:123], v163 offset:49408
ds_read_b64_tr_b16 v[124:125], v164 offset:49152
ds_read_b64_tr_b16 v[126:127], v164 offset:49408
ds_read_b128 v[112:115], v165 offset:4096
s_waitcnt lgkmcnt(11)
v_mfma_f32_16x16x32_bf16 v[96:99], v[240:243], v[240:243], v[96:99]
v_mfma_f32_16x16x32_bf16 v[100:103], v[16:19], v[240:243], v[100:103]
s_waitcnt lgkmcnt(9)
v_mfma_f32_16x16x32_bf16 v[80:83], v[240:243], v[128:131], v[80:83]
v_mfma_f32_16x16x32_bf16 v[104:107], v[16:19], v[128:131], v[104:107]
s_waitcnt lgkmcnt(7)
v_mfma_f32_16x16x32_bf16 v[84:87], v[240:243], v[132:135], v[84:87]
v_mfma_f32_16x16x32_bf16 v[108:111], v[16:19], v[132:135], v[108:111]
s_waitcnt lgkmcnt(6)
v_mfma_f32_16x16x32_bf16 v[88:91], v[116:119], v[128:131], v[88:91]
v_mfma_f32_16x16x32_bf16 v[92:95], v[116:119], v[132:135], v[92:95]
ds_read_b128 v[248:251], v6 offset:4096
ds_read_b64_tr_b16 v[128:129], v163 offset:53248
ds_read_b64_tr_b16 v[130:131], v163 offset:53504
ds_read_b64_tr_b16 v[132:133], v164 offset:53248
ds_read_b64_tr_b16 v[134:135], v164 offset:53504
ds_read_b128 v[116:119], v166 offset:4096
s_waitcnt lgkmcnt(11)
v_mfma_f32_16x16x32_bf16 v[96:99], v[244:247], v[244:247], v[96:99]
v_mfma_f32_16x16x32_bf16 v[100:103], v[16:19], v[244:247], v[100:103]
s_waitcnt lgkmcnt(9)
v_mfma_f32_16x16x32_bf16 v[80:83], v[244:247], v[120:123], v[80:83]
v_mfma_f32_16x16x32_bf16 v[104:107], v[16:19], v[120:123], v[104:107]
s_waitcnt lgkmcnt(7)
v_mfma_f32_16x16x32_bf16 v[84:87], v[244:247], v[124:127], v[84:87]
v_mfma_f32_16x16x32_bf16 v[108:111], v[16:19], v[124:127], v[108:111]
s_waitcnt lgkmcnt(6)
v_mfma_f32_16x16x32_bf16 v[88:91], v[112:115], v[120:123], v[88:91]
v_mfma_f32_16x16x32_bf16 v[92:95], v[112:115], v[124:127], v[92:95]
s_cmp_lg_u32 s32, 6
s_cbranch_scc1 L26
ds_read_b64 v[20:21], v167 offset:4096
ds_read_b64 v[22:23], v167 offset:36864
L26:
s_waitcnt lgkmcnt(5)
v_mfma_f32_16x16x32_bf16 v[96:99], v[248:251], v[248:251], v[96:99]
v_mfma_f32_16x16x32_bf16 v[100:103], v[16:19], v[248:251], v[100:103]
s_waitcnt lgkmcnt(3)
v_mfma_f32_16x16x32_bf16 v[80:83], v[248:251], v[128:131], v[80:83]
v_mfma_f32_16x16x32_bf16 v[104:107], v[16:19], v[128:131], v[104:107]
s_waitcnt lgkmcnt(1)
v_mfma_f32_16x16x32_bf16 v[84:87], v[248:251], v[132:135], v[84:87]
v_mfma_f32_16x16x32_bf16 v[108:111], v[16:19], v[132:135], v[108:111]
s_waitcnt lgkmcnt(0)
v_mfma_f32_16x16x32_bf16 v[88:91], v[116:119], v[128:131], v[88:91]
v_mfma_f32_16x16x32_bf16 v[92:95], v[116:119], v[132:135], v[92:95]
v_cndmask_b32 v4, v96, v97, s[76:77]
v_cndmask_b32 v4, v4, v98, s[78:79]
v_cndmask_b32 v4, v4, v99, s[80:81]
v_mul_f32 v5, 0x3b124925, v100
v_mul_f32 v6, 0x3b124925, v4
v_fma_f32 v6, -v5, v5, v6
v_max_f32 v6, 0, v6
v_add_f32 v6, 0x3727c5ac, v6
v_rsq_f32 v32, v6
s_lshl_b32 s4, s64, 7
s_add_u32 s4, s4, 157696
v_mul_f32_e64 v33, -v5, v32
v_lshl_add_u32 v3, v15, 3, s4
s_mov_b64 exec, s[82:83]
ds_write_b64 v3, v[32:33]
s_mov_b64 exec, -1
s_and_b32 s5, s64, 6
s_lshl_b32 s6, s5, 7
s_add_u32 s6, s6, 157696
s_lshl_b32 s11, s67, 14
s_lshl_b32 s5, s5, 10
s_add_u32 s11, s11, s5
s_add_u32 s11, s11, 0x802000
v_add_u32 v6, s5, v1
v_lshl_add_u32 v4, v14, 5, s6
s_waitcnt lgkmcnt(0)
s_barrier
ds_read_b64 v[148:149], v3
ds_read_b128 v[152:155], v4 offset:0
ds_read_b128 v[156:159], v4 offset:16
ds_read_b128 v[160:163], v4 offset:128
ds_read_b128 v[164:167], v4 offset:144
s_waitcnt lgkmcnt(0)
v_mul_f32 v3, v104, v153
v_fma_f32 v88, v88, v152, v3
v_mul_f32 v3, v104, v155
v_fma_f32 v89, v89, v154, v3
v_mul_f32 v3, v104, v157
v_fma_f32 v90, v90, v156, v3
v_mul_f32 v3, v104, v159
v_fma_f32 v91, v91, v158, v3
v_cvt_pk_bf16_f32 v140, v88, v89
v_cvt_pk_bf16_f32 v141, v90, v91
v_mul_f32 v3, v104, v161
v_fma_f32 v80, v80, v160, v3
v_mul_f32 v3, v104, v163
v_fma_f32 v81, v81, v162, v3
v_mul_f32 v3, v104, v165
v_fma_f32 v82, v82, v164, v3
v_mul_f32 v3, v104, v167
v_fma_f32 v83, v83, v166, v3
v_cvt_pk_bf16_f32 v142, v80, v81
v_cvt_pk_bf16_f32 v143, v82, v83
buffer_store_dwordx4 v[140:143], v1, s[52:55], s11 offen offset:0 sc1
v_mul_f32 v3, v108, v153
v_fma_f32 v92, v92, v152, v3
v_mul_f32 v3, v108, v155
v_fma_f32 v93, v93, v154, v3
v_mul_f32 v3, v108, v157
v_fma_f32 v94, v94, v156, v3
v_mul_f32 v3, v108, v159
v_fma_f32 v95, v95, v158, v3
v_cvt_pk_bf16_f32 v144, v92, v93
v_cvt_pk_bf16_f32 v145, v94, v95
v_mul_f32 v3, v108, v161
v_fma_f32 v84, v84, v160, v3
v_mul_f32 v3, v108, v163
v_fma_f32 v85, v85, v162, v3
v_mul_f32 v3, v108, v165
v_fma_f32 v86, v86, v164, v3
v_mul_f32 v3, v108, v167
v_fma_f32 v87, v87, v166, v3
v_cvt_pk_bf16_f32 v146, v84, v85
v_cvt_pk_bf16_f32 v147, v86, v87
s_mov_b32 exec_lo, 0x10001000
s_mov_b32 exec_hi, 0x10001000
v_mov_b32 v144, 0x3f803f80
v_mov_b32 v145, 0x3f803f80
v_mov_b32 v146, 0x3f803f80
v_mov_b32 v147, 0x3f803f80
s_mov_b32 exec_lo, 0xe000e000
s_mov_b32 exec_hi, 0xe000e000
v_mov_b32 v144, 0
v_mov_b32 v145, 0
v_mov_b32 v146, 0
v_mov_b32 v147, 0
s_mov_b64 exec, -1
buffer_store_dwordx4 v[144:147], v1, s[52:55], s11 offen offset:1024 sc1
ds_write_b128 v6, v[140:143] offset:40960
ds_write_b128 v6, v[144:147] offset:41984
L9:
v_mul_f32 v34, 0x3e8b97f6, v148
v_mul_f32 v35, 0x3e8b97f6, v149
s_lshl_b32 s4, s65, 4
v_add_u32 v13, s4, v15
s_lshl_b32 s7, s101, 4
s_mov_b32 exec_lo, 0x0
s_mov_b32 exec_hi, 0xffff
v_add_u32 v13, s7, v15
s_mov_b64 exec, -1
s_sub_i32 s5, s67, 16
s_max_i32 s5, s5, 0
s_sub_i32 s6, s67, 32
s_cmp_lt_i32 s6, 0
s_cselect_b32 s6, s5, s6
v_writelane_b32 v13, s5, 16
v_writelane_b32 v13, s6, 17
v_and_b32 v13, 255, v13
s_sub_u32 s4, s64, 1
s_cmp_lt_u32 s4, 6
s_cbranch_scc1 L27
v_lshlrev_b32 v3, 3, v13
s_mov_b32 exec_lo, 0x0
s_mov_b32 exec_hi, 0xffff0000
v_add_u32 v3, 0x800, v3
s_mov_b64 exec, -1
s_mov_b32 s4, 0x21000
buffer_load_dwordx2 v[26:27], v3, s[52:55], s4 offen sc1
L27:
s_cmp_eq_u32 s72, 0
s_cbranch_scc1 L28
s_mov_b32 s6, 151552
v_add_u32 v178, s6, v1
ds_write_b128 v178, v[56:59] offset:0
ds_write_b128 v178, v[60:63] offset:1024
ds_write_b128 v178, v[64:67] offset:2048
ds_write_b128 v178, v[68:71] offset:3072
v_lshlrev_b32 v178, 9, v14
v_lshrrev_b32 v179, 2, v15
v_lshl_add_u32 v178, v179, 7, v178
v_and_b32 v179, 3, v0
v_lshl_add_u32 v178, v179, 3, v178
v_add_u32 v178, s6, v178
ds_read_b64_tr_b16 v[104:105], v178 offset:0
ds_read_b64_tr_b16 v[106:107], v178 offset:2048
ds_read_b64_tr_b16 v[108:109], v178 offset:32
ds_read_b64_tr_b16 v[110:111], v178 offset:2080
ds_read_b64_tr_b16 v[112:113], v178 offset:64
ds_read_b64_tr_b16 v[114:115], v178 offset:2112
ds_read_b64_tr_b16 v[116:117], v178 offset:96
ds_read_b64_tr_b16 v[118:119], v178 offset:2144
s_waitcnt lgkmcnt(0)
s_mov_b32 exec_lo, 0x0
s_mov_b32 exec_hi, 0xffff0000
v_mov_b32 v106, 0
v_mov_b32 v107, 0
v_mov_b32 v110, 0
v_mov_b32 v111, 0
v_mov_b32 v114, 0
v_mov_b32 v115, 0
v_mov_b32 v118, 0
v_mov_b32 v119, 0
s_mov_b64 exec, -1
s_mov_b32 s4, s70
buffer_store_dwordx4 v[104:107], v1, s[52:55], s4 offen sc1
s_add_u32 s4, s4, s71
buffer_store_dwordx4 v[108:111], v1, s[52:55], s4 offen sc1
s_add_u32 s4, s4, s71
buffer_store_dwordx4 v[112:115], v1, s[52:55], s4 offen sc1
s_add_u32 s4, s4, s71
buffer_store_dwordx4 v[116:119], v1, s[52:55], s4 offen sc1
L28:
s_and_b32 s5, s64, 1
s_lshl_b32 s5, s5, 4
v_lshlrev_b32 v4, 2, v14
v_sub_u32 v4, v15, v4
v_add_u32 v4, s5, v4
v_mov_b32 v5, 0xff800000
v_mov_b32 v6, 0
v_cmp_gt_i32 s[12:13], 0, v4
v_cmp_gt_i32 s[76:77], 1, v4
v_cmp_gt_i32 s[78:79], 2, v4
v_cmp_gt_i32 s[80:81], 3, v4
v_cndmask_b32 v168, v5, v6, s[12:13]
v_cndmask_b32 v169, v5, v6, s[76:77]
v_cndmask_b32 v170, v5, v6, s[78:79]
v_cndmask_b32 v171, v5, v6, s[80:81]
v_cmp_gt_i32 s[12:13], 16, v4
v_cmp_gt_i32 s[76:77], 17, v4
v_cmp_gt_i32 s[78:79], 18, v4
v_cmp_gt_i32 s[80:81], 19, v4
v_cndmask_b32 v172, v5, v6, s[12:13]
v_cndmask_b32 v173, v5, v6, s[76:77]
v_cndmask_b32 v174, v5, v6, s[78:79]
v_cndmask_b32 v175, v5, v6, s[80:81]
v_cmp_le_i32 s[12:13], 0, v4
v_cmp_le_i32 s[76:77], 1, v4
v_cmp_le_i32 s[78:79], 2, v4
v_cmp_le_i32 s[80:81], 3, v4
v_cndmask_b32 v176, v5, v6, s[12:13]
v_cndmask_b32 v177, v5, v6, s[76:77]
v_cndmask_b32 v178, v5, v6, s[78:79]
v_cndmask_b32 v179, v5, v6, s[80:81]
v_cmp_le_i32 s[12:13], 16, v4
v_cmp_le_i32 s[76:77], 17, v4
v_cmp_le_i32 s[78:79], 18, v4
v_cmp_le_i32 s[80:81], 19, v4
v_cndmask_b32 v180, v5, v6, s[12:13]
v_cndmask_b32 v181, v5, v6, s[76:77]
v_cndmask_b32 v182, v5, v6, s[78:79]
v_cndmask_b32 v183, v5, v6, s[80:81]
v_lshrrev_b32 v3, 1, v14
v_lshlrev_b32 v3, 10, v3
v_sub_u32 v3, 57344, v3
v_add_u32 v8, v8, v3
v_add_u32 v9, v9, v3
s_and_b32 s3, s64, 1
s_cmp_eq_u32 s3, 1
s_cselect_b64 s[12:13], -1, 0
v_cndmask_b32 v10, v8, v9, s[12:13]
s_waitcnt vmcnt(0)
s_waitcnt lgkmcnt(0)
s_barrier
s_lshl_b32 s4, s67, 7
s_cmp_lg_u32 s64, 5
s_cbranch_scc1 L29
s_add_u32 s4, s4, 0x80000
s_mov_b64 exec, 1
buffer_store_dwordx2 v[24:25], v1, s[52:55], s4 offen
s_mov_b64 exec, -1
L29:
s_cmp_lg_u32 s64, 6
s_cbranch_scc1 L30
s_add_u32 s4, s4, 0x0
s_mov_b64 exec, 1
buffer_store_dwordx2 v[24:25], v1, s[52:55], s4 offen sc1
s_mov_b64 exec, -1
L30:
s_cmp_lg_u32 s64, 4
s_cbranch_scc1 L31
s_lshl_b32 s4, s67, 3
s_add_u32 s4, s4, 0x20000
s_mov_b64 exec, 1
buffer_store_dwordx2 v[24:25], v1, s[52:55], s4 offen sc1
s_mov_b64 exec, -1
L31:
s_cmp_eq_u32 s73, 0
s_cselect_b32 s75, 0x10000000, s75
s_cselect_b32 s70, 0x1800000, s70
v_lshrrev_b32 v184, 3, v0
v_mul_lo_u32 v184, v184, s74
v_and_b32 v185, 7, v0
v_lshl_add_u32 v184, v185, 4, v184
s_lshl_b32 s5, s74, 3
s_mov_b32 s4, s75
buffer_load_dwordx4 v[56:59], v184, s[56:59], s4 offen
s_add_u32 s4, s4, s5
buffer_load_dwordx4 v[60:63], v184, s[56:59], s4 offen
s_add_u32 s4, s4, s5
buffer_load_dwordx4 v[64:67], v184, s[56:59], s4 offen
s_add_u32 s4, s4, s5
buffer_load_dwordx4 v[68:71], v184, s[56:59], s4 offen
ds_read_b64_tr_b16 v[104:105], v8 offset:0
ds_read_b64_tr_b16 v[106:107], v8 offset:256
ds_read_b64_tr_b16 v[108:109], v9 offset:0
ds_read_b64_tr_b16 v[110:111], v9 offset:256
ds_read_b64_tr_b16 v[112:113], v8 offset:2048
ds_read_b64_tr_b16 v[114:115], v8 offset:2304
ds_read_b64_tr_b16 v[116:117], v9 offset:2048
ds_read_b64_tr_b16 v[118:119], v9 offset:2304
s_waitcnt lgkmcnt(6)
v_mfma_f32_16x16x32_bf16 v[72:75], v[104:107], v[196:199], 0
v_mfma_f32_16x16x32_bf16 v[128:131], v[104:107], v[16:19], 0
s_waitcnt lgkmcnt(4)
v_mfma_f32_16x16x32_bf16 v[76:79], v[108:111], v[196:199], 0
v_mfma_f32_16x16x32_bf16 v[132:135], v[108:111], v[16:19], 0
ds_read_b64_tr_b16 v[120:121], v8 offset:4096
ds_read_b64_tr_b16 v[122:123], v8 offset:4352
ds_read_b64_tr_b16 v[124:125], v9 offset:4096
ds_read_b64_tr_b16 v[126:127], v9 offset:4352
s_waitcnt lgkmcnt(6)
v_mfma_f32_16x16x32_bf16 v[72:75], v[112:115], v[200:203], v[72:75]
v_mfma_f32_16x16x32_bf16 v[128:131], v[112:115], v[16:19], v[128:131]
s_waitcnt lgkmcnt(4)
v_mfma_f32_16x16x32_bf16 v[76:79], v[116:119], v[200:203], v[76:79]
v_mfma_f32_16x16x32_bf16 v[132:135], v[116:119], v[16:19], v[132:135]
ds_read_b64_tr_b16 v[104:105], v8 offset:6144
ds_read_b64_tr_b16 v[106:107], v8 offset:6400
ds_read_b64_tr_b16 v[108:109], v9 offset:6144
ds_read_b64_tr_b16 v[110:111], v9 offset:6400
s_waitcnt lgkmcnt(6)
v_mfma_f32_16x16x32_bf16 v[72:75], v[120:123], v[204:207], v[72:75]
v_mfma_f32_16x16x32_bf16 v[128:131], v[120:123], v[16:19], v[128:131]
s_waitcnt lgkmcnt(4)
v_mfma_f32_16x16x32_bf16 v[76:79], v[124:127], v[204:207], v[76:79]
v_mfma_f32_16x16x32_bf16 v[132:135], v[124:127], v[16:19], v[132:135]
ds_read_b64_tr_b16 v[112:113], v8 offset:8192
ds_read_b64_tr_b16 v[114:115], v8 offset:8448
ds_read_b64_tr_b16 v[116:117], v9 offset:8192
ds_read_b64_tr_b16 v[118:119], v9 offset:8448
s_waitcnt lgkmcnt(6)
v_mfma_f32_16x16x32_bf16 v[72:75], v[104:107], v[208:211], v[72:75]
v_mfma_f32_16x16x32_bf16 v[128:131], v[104:107], v[16:19], v[128:131]
s_waitcnt lgkmcnt(4)
v_mfma_f32_16x16x32_bf16 v[76:79], v[108:111], v[208:211], v[76:79]
v_mfma_f32_16x16x32_bf16 v[132:135], v[108:111], v[16:19], v[132:135]
ds_read_b64_tr_b16 v[120:121], v8 offset:10240
ds_read_b64_tr_b16 v[122:123], v8 offset:10496
ds_read_b64_tr_b16 v[124:125], v9 offset:10240
ds_read_b64_tr_b16 v[126:127], v9 offset:10496
s_waitcnt lgkmcnt(6)
v_mfma_f32_16x16x32_bf16 v[72:75], v[112:115], v[212:215], v[72:75]
v_mfma_f32_16x16x32_bf16 v[128:131], v[112:115], v[16:19], v[128:131]
s_waitcnt lgkmcnt(4)
v_mfma_f32_16x16x32_bf16 v[76:79], v[116:119], v[212:215], v[76:79]
v_mfma_f32_16x16x32_bf16 v[132:135], v[116:119], v[16:19], v[132:135]
ds_read_b64_tr_b16 v[104:105], v8 offset:12288
ds_read_b64_tr_b16 v[106:107], v8 offset:12544
ds_read_b64_tr_b16 v[108:109], v9 offset:12288
ds_read_b64_tr_b16 v[110:111], v9 offset:12544
s_waitcnt lgkmcnt(6)
v_mfma_f32_16x16x32_bf16 v[72:75], v[120:123], v[216:219], v[72:75]
v_mfma_f32_16x16x32_bf16 v[128:131], v[120:123], v[16:19], v[128:131]
s_waitcnt lgkmcnt(4)
v_mfma_f32_16x16x32_bf16 v[76:79], v[124:127], v[216:219], v[76:79]
v_mfma_f32_16x16x32_bf16 v[132:135], v[124:127], v[16:19], v[132:135]
ds_read_b64_tr_b16 v[112:113], v8 offset:14336
ds_read_b64_tr_b16 v[114:115], v8 offset:14592
ds_read_b64_tr_b16 v[116:117], v9 offset:14336
ds_read_b64_tr_b16 v[118:119], v9 offset:14592
s_waitcnt lgkmcnt(6)
v_mfma_f32_16x16x32_bf16 v[72:75], v[104:107], v[220:223], v[72:75]
v_mfma_f32_16x16x32_bf16 v[128:131], v[104:107], v[16:19], v[128:131]
s_waitcnt lgkmcnt(4)
v_mfma_f32_16x16x32_bf16 v[76:79], v[108:111], v[220:223], v[76:79]
v_mfma_f32_16x16x32_bf16 v[132:135], v[108:111], v[16:19], v[132:135]
ds_read_b64_tr_b16 v[120:121], v8 offset:16384
ds_read_b64_tr_b16 v[122:123], v8 offset:16640
ds_read_b64_tr_b16 v[124:125], v9 offset:16384
ds_read_b64_tr_b16 v[126:127], v9 offset:16640
s_waitcnt lgkmcnt(6)
v_mfma_f32_16x16x32_bf16 v[72:75], v[112:115], v[224:227], v[72:75]
v_mfma_f32_16x16x32_bf16 v[128:131], v[112:115], v[16:19], v[128:131]
s_waitcnt lgkmcnt(4)
v_mfma_f32_16x16x32_bf16 v[76:79], v[116:119], v[224:227], v[76:79]
v_mfma_f32_16x16x32_bf16 v[132:135], v[116:119], v[16:19], v[132:135]
ds_read_b64_tr_b16 v[104:105], v8 offset:18432
ds_read_b64_tr_b16 v[106:107], v8 offset:18688
ds_read_b64_tr_b16 v[108:109], v9 offset:18432
ds_read_b64_tr_b16 v[110:111], v9 offset:18688
s_waitcnt lgkmcnt(6)
v_mfma_f32_16x16x32_bf16 v[72:75], v[120:123], v[228:231], v[72:75]
v_mfma_f32_16x16x32_bf16 v[128:131], v[120:123], v[16:19], v[128:131]
s_waitcnt lgkmcnt(4)
v_mfma_f32_16x16x32_bf16 v[76:79], v[124:127], v[228:231], v[76:79]
v_mfma_f32_16x16x32_bf16 v[132:135], v[124:127], v[16:19], v[132:135]
ds_read_b64_tr_b16 v[112:113], v8 offset:20480
ds_read_b64_tr_b16 v[114:115], v8 offset:20736
ds_read_b64_tr_b16 v[116:117], v9 offset:20480
ds_read_b64_tr_b16 v[118:119], v9 offset:20736
s_waitcnt lgkmcnt(6)
v_mfma_f32_16x16x32_bf16 v[72:75], v[104:107], v[232:235], v[72:75]
v_mfma_f32_16x16x32_bf16 v[128:131], v[104:107], v[16:19], v[128:131]
s_waitcnt lgkmcnt(4)
v_mfma_f32_16x16x32_bf16 v[76:79], v[108:111], v[232:235], v[76:79]
v_mfma_f32_16x16x32_bf16 v[132:135], v[108:111], v[16:19], v[132:135]
ds_read_b64_tr_b16 v[120:121], v8 offset:22528
ds_read_b64_tr_b16 v[122:123], v8 offset:22784
ds_read_b64_tr_b16 v[124:125], v9 offset:22528
ds_read_b64_tr_b16 v[126:127], v9 offset:22784
s_waitcnt lgkmcnt(6)
v_mfma_f32_16x16x32_bf16 v[72:75], v[112:115], v[236:239], v[72:75]
v_mfma_f32_16x16x32_bf16 v[128:131], v[112:115], v[16:19], v[128:131]
s_waitcnt lgkmcnt(4)
v_mfma_f32_16x16x32_bf16 v[76:79], v[116:119], v[236:239], v[76:79]
v_mfma_f32_16x16x32_bf16 v[132:135], v[116:119], v[16:19], v[132:135]
ds_read_b64_tr_b16 v[104:105], v8 offset:24576
ds_read_b64_tr_b16 v[106:107], v8 offset:24832
ds_read_b64_tr_b16 v[108:109], v9 offset:24576
ds_read_b64_tr_b16 v[110:111], v9 offset:24832
s_waitcnt lgkmcnt(6)
v_mfma_f32_16x16x32_bf16 v[72:75], v[120:123], v[240:243], v[72:75]
v_mfma_f32_16x16x32_bf16 v[128:131], v[120:123], v[16:19], v[128:131]
s_waitcnt lgkmcnt(4)
v_mfma_f32_16x16x32_bf16 v[76:79], v[124:127], v[240:243], v[76:79]
v_mfma_f32_16x16x32_bf16 v[132:135], v[124:127], v[16:19], v[132:135]
ds_read_b64_tr_b16 v[112:113], v8 offset:26624
ds_read_b64_tr_b16 v[114:115], v8 offset:26880
ds_read_b64_tr_b16 v[116:117], v9 offset:26624
ds_read_b64_tr_b16 v[118:119], v9 offset:26880
s_waitcnt lgkmcnt(6)
v_mfma_f32_16x16x32_bf16 v[72:75], v[104:107], v[244:247], v[72:75]
v_mfma_f32_16x16x32_bf16 v[128:131], v[104:107], v[16:19], v[128:131]
s_waitcnt lgkmcnt(4)
v_mfma_f32_16x16x32_bf16 v[76:79], v[108:111], v[244:247], v[76:79]
v_mfma_f32_16x16x32_bf16 v[132:135], v[108:111], v[16:19], v[132:135]
s_waitcnt lgkmcnt(2)
v_mfma_f32_16x16x32_bf16 v[72:75], v[112:115], v[248:251], v[72:75]
v_mfma_f32_16x16x32_bf16 v[128:131], v[112:115], v[16:19], v[128:131]
s_waitcnt lgkmcnt(0)
v_mfma_f32_16x16x32_bf16 v[76:79], v[116:119], v[248:251], v[76:79]
v_mfma_f32_16x16x32_bf16 v[132:135], v[116:119], v[16:19], v[132:135]
s_lshr_b32 s4, s64, 1
s_lshl_b32 s4, s4, 11
v_add_u32 v3, s4, v1
s_nop 1
v_mul_f32 v128, v128, v35
v_fma_f32 v72, v72, v34, v128
v_mul_f32 v129, v129, v35
v_fma_f32 v73, v73, v34, v129
v_mul_f32 v130, v130, v35
v_fma_f32 v74, v74, v34, v130
v_mul_f32 v131, v131, v35
v_fma_f32 v75, v75, v34, v131
v_mul_f32 v132, v132, v35
v_fma_f32 v76, v76, v34, v132
v_mul_f32 v133, v133, v35
v_fma_f32 v77, v77, v34, v133
v_mul_f32 v134, v134, v35
v_fma_f32 v78, v78, v34, v134
v_mul_f32 v135, v135, v35
v_fma_f32 v79, v79, v34, v135
v_cvt_pk_bf16_f32 v28, v72, v73
v_cvt_pk_bf16_f32 v29, v74, v75
v_cvt_pk_bf16_f32 v30, v76, v77
v_cvt_pk_bf16_f32 v31, v78, v79
s_mov_b32 exec_lo, 0x0
s_mov_b32 exec_hi, 0xffff0000
v_mov_b32 v30, 0
v_mov_b32 v31, 0
s_mov_b64 exec, -1
v_mov_b32 v240, v168
v_mov_b32 v241, v169
v_mov_b32 v242, v170
v_mov_b32 v243, v171
v_mov_b32 v244, v172
v_mov_b32 v245, v173
v_mov_b32 v246, v174
v_mov_b32 v247, v175
v_mov_b32 v248, v176
v_mov_b32 v249, v177
v_mov_b32 v250, v178
v_mov_b32 v251, v179
v_mov_b32 v252, v180
v_mov_b32 v253, v181
v_mov_b32 v254, v182
v_mov_b32 v255, v183
s_lshr_b32 s4, s64, 1
s_cmp_eq_u32 s4, 1
s_cbranch_scc1 L33
s_cmp_eq_u32 s4, 2
s_cbranch_scc1 L34
s_cmp_eq_u32 s4, 3
s_cbranch_scc1 L35
ds_read_b128 v[176:179], v3 offset:16384
ds_read_b128 v[180:183], v3 offset:17408
s_waitcnt lgkmcnt(1)
v_mfma_f32_16x16x32_bf16 v[168:171], v[176:179], v[28:31], v[248:251]
ds_read_b128 v[208:211], v3 offset:40960
s_waitcnt lgkmcnt(1)
v_mfma_f32_16x16x32_bf16 v[172:175], v[180:183], v[28:31], v[252:255]
ds_read_b128 v[212:215], v3 offset:41984
s_nop 3
v_max3_f32 v6, v168, v169, v170
s_nop 1
v_max3_f32 v7, v171, v172, v173
v_max3_f32 v6, v6, v174, v175
v_max_f32 v6, v6, v7
v_mov_b32 v7, v6
s_nop 1
v_permlane32_swap_b32 v6, v7
v_max_f32 v6, v6, v7
v_mov_b32 v7, v6
s_nop 1
v_permlane16_swap_b32 v6, v7
v_max_f32 v10, v6, v7
v_sub_f32 v168, v168, v10
v_sub_f32 v169, v169, v10
v_sub_f32 v170, v170, v10
v_sub_f32 v171, v171, v10
v_sub_f32 v172, v172, v10
v_sub_f32 v173, v173, v10
v_sub_f32 v174, v174, v10
v_sub_f32 v175, v175, v10
v_exp_f32 v168, v168
v_exp_f32 v169, v169
v_exp_f32 v170, v170
v_exp_f32 v171, v171
v_exp_f32 v172, v172
v_exp_f32 v173, v173
v_exp_f32 v174, v174
v_exp_f32 v175, v175
v_cvt_pk_bf16_f32 v168, v168, v169
v_cvt_pk_bf16_f32 v169, v170, v171
v_cvt_pk_bf16_f32 v170, v172, v173
v_cvt_pk_bf16_f32 v171, v174, v175
s_waitcnt lgkmcnt(1)
s_nop 0
v_mfma_f32_16x16x32_bf16 v[32:35], v[208:211], v[168:171], 0
s_waitcnt lgkmcnt(0)
v_mfma_f32_16x16x32_bf16 v[36:39], v[212:215], v[168:171], 0
s_cmp_lg_u32 s64, 0
s_cbranch_scc1 L37
v_or_b32 v48, s100, v24
v_mov_b32 v49, v25
v_cmp_eq_u64 vcc, v[26:27], v[48:49]
v_lshlrev_b32 v13, 7, v13
v_mov_b32 v48, 0x80000
v_cndmask_b32 v48, 0, v48, vcc
v_or_b32 v13, v13, v48
s_cmp_eq_u32 s65, 0
s_cbranch_scc1 L37
s_cmp_eq_u32 s65, 1
s_cselect_b32 s5, 1, 3
s_lshl_b32 s5, s5, 16
s_mov_b32 exec_hi, 0
s_mov_b32 exec_lo, s5
s_mov_b32 s4, 0x0
s_mov_b32 s10, 0
L38:
buffer_load_dwordx2 v[26:27], v13, s[52:55], s4 offen sc1
s_add_u32 s10, s10, 1
s_cmp_lg_u32 s10, 0x1000
s_cbranch_scc1 L40
v_and_b32 v13, 0x7ffff, v13
L40:
s_cmp_gt_u32 s10, 0x40000
s_waitcnt vmcnt(0)
s_cbranch_scc1 L39
v_cmp_ne_u64 vcc, v[26:27], v[24:25]
s_cbranch_vccnz L38
L39:
s_mov_b64 exec, -1
L37:
s_lshr_b32 s4, s64, 2
s_and_b32 s5, s64, 3
s_add_u32 s6, s65, s4
s_lshl_b32 s7, s4, 4
s_add_u32 s7, s7, s67
s_sub_u32 s7, s7, 32
s_lshl_b32 s7, s7, 14
s_lshl_b32 s8, s5, 12
s_add_u32 s7, s7, s8
s_add_u32 s7, s7, 0x800000
s_cmp_lt_u32 s6, 2
s_cselect_b32 s7, 0x1700000, s7
s_lshl_b32 s8, s4, 13
s_and_b32 s9, s5, 1
s_lshl_b32 s9, s9, 12
s_add_u32 s8, s8, s9
s_cmp_ge_u32 s5, 2
s_cselect_b32 s9, 24576, 0
s_add_u32 m0, s8, s9
s_barrier
buffer_load_dwordx4 v1, s[52:55], s7 offen offset:0 sc1 lds
buffer_load_dwordx4 v1, s[52:55], s7 offen offset:1024 sc1 lds
buffer_load_dwordx4 v1, s[52:55], s7 offen offset:2048 sc1 lds
buffer_load_dwordx4 v1, s[52:55], s7 offen offset:3072 sc1 lds
s_waitcnt vmcnt(4)
s_cmp_eq_u32 s73, 0
s_cbranch_scc1 L41
s_lshl_b32 s6, s64, 12
s_add_u32 s6, s6, 86016
v_add_u32 v178, s6, v1
ds_write_b128 v178, v[56:59] offset:0
ds_write_b128 v178, v[60:63] offset:1024
ds_write_b128 v178, v[64:67] offset:2048
ds_write_b128 v178, v[68:71] offset:3072
v_lshlrev_b32 v178, 10, v14
v_lshrrev_b32 v179, 2, v15
v_lshl_add_u32 v178, v179, 7, v178
v_and_b32 v179, 3, v0
v_lshl_add_u32 v178, v179, 3, v178
v_add_u32 v178, s6, v178
ds_read_b64_tr_b16 v[72:73], v178 offset:0
ds_read_b64_tr_b16 v[74:75], v178 offset:512
ds_read_b64_tr_b16 v[76:77], v178 offset:32
ds_read_b64_tr_b16 v[78:79], v178 offset:544
ds_read_b64_tr_b16 v[80:81], v178 offset:64
ds_read_b64_tr_b16 v[82:83], v178 offset:576
ds_read_b64_tr_b16 v[84:85], v178 offset:96
ds_read_b64_tr_b16 v[86:87], v178 offset:608
s_waitcnt lgkmcnt(0)
L41:
s_waitcnt vmcnt(0)
s_barrier
ds_read_b32 v12, v11
ds_read_b128 v[40:43], v3 offset:0
ds_read_b128 v[44:47], v3 offset:1024
ds_read_b128 v[48:51], v3 offset:2048
ds_read_b128 v[52:55], v3 offset:3072
ds_read_b128 v[56:59], v3 offset:4096
ds_read_b128 v[60:63], v3 offset:5120
ds_read_b128 v[88:91], v3 offset:6144
ds_read_b128 v[92:95], v3 offset:7168
ds_read_b128 v[96:99], v3 offset:8192
ds_read_b128 v[100:103], v3 offset:9216
s_mov_b32 s4, s70
buffer_store_dwordx4 v[72:75], v1, s[52:55], s4 offen sc1
s_add_u32 s4, s4, s71
buffer_store_dwordx4 v[76:79], v1, s[52:55], s4 offen sc1
s_add_u32 s4, s4, s71
buffer_store_dwordx4 v[80:83], v1, s[52:55], s4 offen sc1
s_add_u32 s4, s4, s71
buffer_store_dwordx4 v[84:87], v1, s[52:55], s4 offen sc1
s_waitcnt lgkmcnt(10)
v_readfirstlane_b32 s68, v12
s_cmp_lg_u32 s64, 7
s_cselect_b32 s4, s68, 0
s_cmp_lg_u32 s4, 0
s_cselect_b32 s20, s17, 0x1800000
s_waitcnt lgkmcnt(9)
v_mfma_f32_16x16x32_bf16 v[104:107], v[40:43], v[28:31], v[240:243]
ds_read_b128 v[40:43], v3 offset:10240
s_waitcnt lgkmcnt(9)
v_mfma_f32_16x16x32_bf16 v[108:111], v[44:47], v[28:31], v[244:247]
ds_read_b128 v[44:47], v3 offset:11264
s_waitcnt lgkmcnt(9)
v_mfma_f32_16x16x32_bf16 v[112:115], v[48:51], v[28:31], 0
ds_read_b128 v[48:51], v3 offset:12288
s_waitcnt lgkmcnt(9)
v_mfma_f32_16x16x32_bf16 v[116:119], v[52:55], v[28:31], 0
ds_read_b128 v[52:55], v3 offset:13312
s_waitcnt lgkmcnt(9)
v_mfma_f32_16x16x32_bf16 v[120:123], v[56:59], v[28:31], 0
ds_read_b128 v[56:59], v3 offset:14336
s_waitcnt lgkmcnt(9)
v_mfma_f32_16x16x32_bf16 v[124:127], v[60:63], v[28:31], 0
ds_read_b128 v[60:63], v3 offset:15360
s_waitcnt lgkmcnt(9)
v_mfma_f32_16x16x32_bf16 v[128:131], v[88:91], v[28:31], 0
ds_read_b128 v[88:91], v3 offset:24576
s_waitcnt lgkmcnt(9)
v_mfma_f32_16x16x32_bf16 v[132:135], v[92:95], v[28:31], 0
ds_read_b128 v[92:95], v3 offset:25600
s_waitcnt lgkmcnt(9)
v_mfma_f32_16x16x32_bf16 v[136:139], v[96:99], v[28:31], 0
ds_read_b128 v[96:99], v3 offset:26624
s_waitcnt lgkmcnt(9)
v_mfma_f32_16x16x32_bf16 v[140:143], v[100:103], v[28:31], 0
ds_read_b128 v[100:103], v3 offset:27648
s_waitcnt lgkmcnt(9)
v_mfma_f32_16x16x32_bf16 v[144:147], v[40:43], v[28:31], 0
ds_read_b128 v[40:43], v3 offset:28672
s_waitcnt lgkmcnt(9)
v_mfma_f32_16x16x32_bf16 v[148:151], v[44:47], v[28:31], 0
ds_read_b128 v[44:47], v3 offset:29696
s_waitcnt lgkmcnt(9)
v_mfma_f32_16x16x32_bf16 v[152:155], v[48:51], v[28:31], 0
ds_read_b128 v[48:51], v3 offset:30720
s_waitcnt lgkmcnt(9)
v_mfma_f32_16x16x32_bf16 v[156:159], v[52:55], v[28:31], 0
ds_read_b128 v[52:55], v3 offset:31744
s_waitcnt lgkmcnt(9)
v_mfma_f32_16x16x32_bf16 v[160:163], v[56:59], v[28:31], 0
ds_read_b128 v[56:59], v3 offset:32768
s_waitcnt lgkmcnt(9)
v_mfma_f32_16x16x32_bf16 v[164:167], v[60:63], v[28:31], 0
ds_read_b128 v[60:63], v3 offset:33792
s_cmp_ge_u32 s65, 2
s_cbranch_scc1 L42
s_lshl_b32 s4, s65, 3
s_sub_u32 s4, 16, s4
s_cmp_gt_i32 s4, 0
s_cbranch_scc0 L42
v_mov_b32 v104, v5
v_mov_b32 v105, v5
v_mov_b32 v106, v5
v_mov_b32 v107, v5
s_cmp_gt_i32 s4, 1
s_cbranch_scc0 L42
v_mov_b32 v108, v5
v_mov_b32 v109, v5
v_mov_b32 v110, v5
v_mov_b32 v111, v5
s_cmp_gt_i32 s4, 2
s_cbranch_scc0 L42
v_mov_b32 v112, v5
v_mov_b32 v113, v5
v_mov_b32 v114, v5
v_mov_b32 v115, v5
s_cmp_gt_i32 s4, 3
s_cbranch_scc0 L42
v_mov_b32 v116, v5
v_mov_b32 v117, v5
v_mov_b32 v118, v5
v_mov_b32 v119, v5
s_cmp_gt_i32 s4, 4
s_cbranch_scc0 L42
v_mov_b32 v120, v5
v_mov_b32 v121, v5
v_mov_b32 v122, v5
v_mov_b32 v123, v5
s_cmp_gt_i32 s4, 5
s_cbranch_scc0 L42
v_mov_b32 v124, v5
v_mov_b32 v125, v5
v_mov_b32 v126, v5
v_mov_b32 v127, v5
s_cmp_gt_i32 s4, 6
s_cbranch_scc0 L42
v_mov_b32 v128, v5
v_mov_b32 v129, v5
v_mov_b32 v130, v5
v_mov_b32 v131, v5
s_cmp_gt_i32 s4, 7
s_cbranch_scc0 L42
v_mov_b32 v132, v5
v_mov_b32 v133, v5
v_mov_b32 v134, v5
v_mov_b32 v135, v5
s_cmp_gt_i32 s4, 8
s_cbranch_scc0 L42
v_mov_b32 v136, v5
v_mov_b32 v137, v5
v_mov_b32 v138, v5
v_mov_b32 v139, v5
s_cmp_gt_i32 s4, 9
s_cbranch_scc0 L42
v_mov_b32 v140, v5
v_mov_b32 v141, v5
v_mov_b32 v142, v5
v_mov_b32 v143, v5
s_cmp_gt_i32 s4, 10
s_cbranch_scc0 L42
v_mov_b32 v144, v5
v_mov_b32 v145, v5
v_mov_b32 v146, v5
v_mov_b32 v147, v5
s_cmp_gt_i32 s4, 11
s_cbranch_scc0 L42
v_mov_b32 v148, v5
v_mov_b32 v149, v5
v_mov_b32 v150, v5
v_mov_b32 v151, v5
s_cmp_gt_i32 s4, 12
s_cbranch_scc0 L42
v_mov_b32 v152, v5
v_mov_b32 v153, v5
v_mov_b32 v154, v5
v_mov_b32 v155, v5
s_cmp_gt_i32 s4, 13
s_cbranch_scc0 L42
v_mov_b32 v156, v5
v_mov_b32 v157, v5
v_mov_b32 v158, v5
v_mov_b32 v159, v5
s_cmp_gt_i32 s4, 14
s_cbranch_scc0 L42
v_mov_b32 v160, v5
v_mov_b32 v161, v5
v_mov_b32 v162, v5
v_mov_b32 v163, v5
s_cmp_gt_i32 s4, 15
s_cbranch_scc0 L42
v_mov_b32 v164, v5
v_mov_b32 v165, v5
v_mov_b32 v166, v5
v_mov_b32 v167, v5
L42:
v_max3_f32 v6, v104, v105, v106
v_max3_f32 v7, v107, v108, v109
v_max3_f32 v6, v6, v110, v111
v_max3_f32 v7, v7, v112, v113
v_max3_f32 v6, v6, v114, v115
v_max3_f32 v7, v7, v116, v117
v_max3_f32 v6, v6, v118, v119
v_max3_f32 v7, v7, v120, v121
v_max3_f32 v6, v6, v122, v123
v_max3_f32 v7, v7, v124, v125
v_max3_f32 v6, v6, v126, v127
v_max3_f32 v7, v7, v128, v129
v_max3_f32 v6, v6, v130, v131
v_max3_f32 v7, v7, v132, v133
v_max3_f32 v6, v6, v134, v135
v_max3_f32 v7, v7, v136, v137
v_max3_f32 v6, v6, v138, v139
v_max3_f32 v7, v7, v140, v141
v_max3_f32 v6, v6, v142, v143
v_max3_f32 v7, v7, v144, v145
v_max3_f32 v6, v6, v146, v147
v_max3_f32 v7, v7, v148, v149
v_max3_f32 v6, v6, v150, v151
v_max3_f32 v7, v7, v152, v153
v_max3_f32 v6, v6, v154, v155
v_max3_f32 v7, v7, v156, v157
v_max3_f32 v6, v6, v158, v159
v_max3_f32 v7, v7, v160, v161
v_max3_f32 v6, v6, v162, v163
v_max3_f32 v7, v7, v164, v165
v_max3_f32 v6, v6, v166, v167
v_max_f32 v7, v7, v10
v_max_f32 v6, v6, v7
v_mov_b32 v7, v6
s_nop 1
v_permlane32_swap_b32 v6, v7
v_max_f32 v6, v6, v7
v_mov_b32 v7, v6
s_nop 1
v_permlane16_swap_b32 v6, v7
v_max_f32 v9, v6, v7
v_sub_f32 v7, v10, v9
v_exp_f32 v7, v7
s_waitcnt vmcnt(0)
s_waitcnt lgkmcnt(0)
v_mov_b32 v12, 1
s_mov_b64 exec, 1
ds_add_rtn_u32 v12, v11, v12 offset:16
s_waitcnt lgkmcnt(0)
v_readfirstlane_b32 s5, v12
s_nop 0
s_cmp_lg_u32 s5, 7
s_cbranch_scc1 L43
s_lshl_b32 s4, s67, 3
s_add_u32 s4, s4, 0x22000
buffer_store_dwordx2 v[24:25], v1, s[52:55], s4 offen sc1
L43:
s_mov_b64 exec, -1
v_mul_f32 v32, v32, v7
v_mul_f32 v33, v33, v7
v_mul_f32 v34, v34, v7
v_mul_f32 v35, v35, v7
v_mul_f32 v36, v36, v7
v_mul_f32 v37, v37, v7
v_mul_f32 v38, v38, v7
v_mul_f32 v39, v39, v7
v_sub_f32 v104, v104, v9
v_sub_f32 v105, v105, v9
v_sub_f32 v106, v106, v9
v_sub_f32 v107, v107, v9
v_sub_f32 v108, v108, v9
v_sub_f32 v109, v109, v9
v_sub_f32 v110, v110, v9
v_sub_f32 v111, v111, v9
v_exp_f32 v104, v104
v_exp_f32 v105, v105
buffer_load_dwordx4 v[176:179], v1, s[52:55], s20 offen offset:0 sc1
v_exp_f32 v106, v106
v_exp_f32 v107, v107
buffer_load_dwordx4 v[180:183], v1, s[52:55], s20 offen offset:1024 sc1
v_exp_f32 v108, v108
v_exp_f32 v109, v109
buffer_load_dwordx4 v[184:187], v1, s[52:55], s20 offen offset:2048 sc1
v_exp_f32 v110, v110
v_exp_f32 v111, v111
v_cvt_pk_bf16_f32 v104, v104, v105
v_cvt_pk_bf16_f32 v105, v106, v107
v_cvt_pk_bf16_f32 v106, v108, v109
v_cvt_pk_bf16_f32 v107, v110, v111
s_nop 1
v_mfma_f32_16x16x32_bf16 v[32:35], v[88:91], v[104:107], v[32:35]
ds_read_b128 v[88:91], v3 offset:34816
v_mfma_f32_16x16x32_bf16 v[36:39], v[92:95], v[104:107], v[36:39]
ds_read_b128 v[92:95], v3 offset:35840
v_sub_f32 v112, v112, v9
v_sub_f32 v113, v113, v9
v_sub_f32 v114, v114, v9
v_sub_f32 v115, v115, v9
v_sub_f32 v116, v116, v9
v_sub_f32 v117, v117, v9
v_sub_f32 v118, v118, v9
v_sub_f32 v119, v119, v9
v_exp_f32 v112, v112
v_exp_f32 v113, v113
buffer_load_dwordx4 v[188:191], v1, s[52:55], s20 offen offset:3072 sc1
v_exp_f32 v114, v114
v_exp_f32 v115, v115
s_add_u32 s9, s20, 4096
buffer_load_dwordx4 v[192:195], v1, s[52:55], s9 offen offset:0 sc1
v_exp_f32 v116, v116
v_exp_f32 v117, v117
s_add_u32 s9, s20, 4096
buffer_load_dwordx4 v[196:199], v1, s[52:55], s9 offen offset:1024 sc1
v_exp_f32 v118, v118
v_exp_f32 v119, v119
v_cvt_pk_bf16_f32 v112, v112, v113
v_cvt_pk_bf16_f32 v113, v114, v115
v_cvt_pk_bf16_f32 v114, v116, v117
v_cvt_pk_bf16_f32 v115, v118, v119
s_nop 1
v_mfma_f32_16x16x32_bf16 v[32:35], v[96:99], v[112:115], v[32:35]
ds_read_b128 v[96:99], v3 offset:36864
v_mfma_f32_16x16x32_bf16 v[36:39], v[100:103], v[112:115], v[36:39]
ds_read_b128 v[100:103], v3 offset:37888
v_sub_f32 v120, v120, v9
v_sub_f32 v121, v121, v9
v_sub_f32 v122, v122, v9
v_sub_f32 v123, v123, v9
v_sub_f32 v124, v124, v9
v_sub_f32 v125, v125, v9
v_sub_f32 v126, v126, v9
v_sub_f32 v127, v127, v9
v_exp_f32 v120, v120
v_exp_f32 v121, v121
s_add_u32 s9, s20, 4096
buffer_load_dwordx4 v[200:203], v1, s[52:55], s9 offen offset:2048 sc1
v_exp_f32 v122, v122
v_exp_f32 v123, v123
s_add_u32 s9, s20, 4096
buffer_load_dwordx4 v[204:207], v1, s[52:55], s9 offen offset:3072 sc1
v_exp_f32 v124, v124
v_exp_f32 v125, v125
s_add_u32 s9, s20, 8192
buffer_load_dwordx4 v[208:211], v1, s[52:55], s9 offen offset:0 sc1
v_exp_f32 v126, v126
v_exp_f32 v127, v127
v_cvt_pk_bf16_f32 v120, v120, v121
v_cvt_pk_bf16_f32 v121, v122, v123
v_cvt_pk_bf16_f32 v122, v124, v125
v_cvt_pk_bf16_f32 v123, v126, v127
s_nop 1
v_mfma_f32_16x16x32_bf16 v[32:35], v[40:43], v[120:123], v[32:35]
ds_read_b128 v[40:43], v3 offset:38912
v_mfma_f32_16x16x32_bf16 v[36:39], v[44:47], v[120:123], v[36:39]
ds_read_b128 v[44:47], v3 offset:39936
v_sub_f32 v128, v128, v9
v_sub_f32 v129, v129, v9
v_sub_f32 v130, v130, v9
v_sub_f32 v131, v131, v9
v_sub_f32 v132, v132, v9
v_sub_f32 v133, v133, v9
v_sub_f32 v134, v134, v9
v_sub_f32 v135, v135, v9
v_exp_f32 v128, v128
v_exp_f32 v129, v129
s_add_u32 s9, s20, 8192
buffer_load_dwordx4 v[212:215], v1, s[52:55], s9 offen offset:1024 sc1
v_exp_f32 v130, v130
v_exp_f32 v131, v131
s_add_u32 s9, s20, 8192
buffer_load_dwordx4 v[216:219], v1, s[52:55], s9 offen offset:2048 sc1
v_exp_f32 v132, v132
v_exp_f32 v133, v133
s_add_u32 s9, s20, 8192
buffer_load_dwordx4 v[220:223], v1, s[52:55], s9 offen offset:3072 sc1
v_exp_f32 v134, v134
v_exp_f32 v135, v135
v_cvt_pk_bf16_f32 v128, v128, v129
v_cvt_pk_bf16_f32 v129, v130, v131
v_cvt_pk_bf16_f32 v130, v132, v133
v_cvt_pk_bf16_f32 v131, v134, v135
s_nop 1
v_mfma_f32_16x16x32_bf16 v[32:35], v[48:51], v[128:131], v[32:35]
v_mfma_f32_16x16x32_bf16 v[36:39], v[52:55], v[128:131], v[36:39]
v_sub_f32 v136, v136, v9
v_sub_f32 v137, v137, v9
v_sub_f32 v138, v138, v9
v_sub_f32 v139, v139, v9
v_sub_f32 v140, v140, v9
v_sub_f32 v141, v141, v9
v_sub_f32 v142, v142, v9
v_sub_f32 v143, v143, v9
v_exp_f32 v136, v136
v_exp_f32 v137, v137
s_add_u32 s9, s20, 12288
buffer_load_dwordx4 v[224:227], v1, s[52:55], s9 offen offset:0 sc1
v_exp_f32 v138, v138
v_exp_f32 v139, v139
s_add_u32 s9, s20, 12288
buffer_load_dwordx4 v[228:231], v1, s[52:55], s9 offen offset:1024 sc1
v_exp_f32 v140, v140
v_exp_f32 v141, v141
s_add_u32 s9, s20, 12288
buffer_load_dwordx4 v[232:235], v1, s[52:55], s9 offen offset:2048 sc1
v_exp_f32 v142, v142
v_exp_f32 v143, v143
v_cvt_pk_bf16_f32 v136, v136, v137
v_cvt_pk_bf16_f32 v137, v138, v139
v_cvt_pk_bf16_f32 v138, v140, v141
v_cvt_pk_bf16_f32 v139, v142, v143
s_nop 1
v_mfma_f32_16x16x32_bf16 v[32:35], v[56:59], v[136:139], v[32:35]
v_mfma_f32_16x16x32_bf16 v[36:39], v[60:63], v[136:139], v[36:39]
v_sub_f32 v144, v144, v9
v_sub_f32 v145, v145, v9
v_sub_f32 v146, v146, v9
v_sub_f32 v147, v147, v9
v_sub_f32 v148, v148, v9
v_sub_f32 v149, v149, v9
v_sub_f32 v150, v150, v9
v_sub_f32 v151, v151, v9
v_exp_f32 v144, v144
v_exp_f32 v145, v145
s_add_u32 s9, s20, 12288
buffer_load_dwordx4 v[236:239], v1, s[52:55], s9 offen offset:3072 sc1
v_exp_f32 v146, v146
v_exp_f32 v147, v147
v_exp_f32 v148, v148
v_exp_f32 v149, v149
v_exp_f32 v150, v150
v_exp_f32 v151, v151
v_cvt_pk_bf16_f32 v144, v144, v145
v_cvt_pk_bf16_f32 v145, v146, v147
v_cvt_pk_bf16_f32 v146, v148, v149
v_cvt_pk_bf16_f32 v147, v150, v151
s_waitcnt lgkmcnt(5)
s_nop 0
v_mfma_f32_16x16x32_bf16 v[32:35], v[88:91], v[144:147], v[32:35]
s_waitcnt lgkmcnt(4)
v_mfma_f32_16x16x32_bf16 v[36:39], v[92:95], v[144:147], v[36:39]
v_sub_f32 v152, v152, v9
v_sub_f32 v153, v153, v9
v_sub_f32 v154, v154, v9
v_sub_f32 v155, v155, v9
v_sub_f32 v156, v156, v9
v_sub_f32 v157, v157, v9
v_sub_f32 v158, v158, v9
v_sub_f32 v159, v159, v9
v_exp_f32 v152, v152
v_exp_f32 v153, v153
v_exp_f32 v154, v154
v_exp_f32 v155, v155
v_exp_f32 v156, v156
v_exp_f32 v157, v157
v_exp_f32 v158, v158
v_exp_f32 v159, v159
v_cvt_pk_bf16_f32 v152, v152, v153
v_cvt_pk_bf16_f32 v153, v154, v155
v_cvt_pk_bf16_f32 v154, v156, v157
v_cvt_pk_bf16_f32 v155, v158, v159
s_waitcnt lgkmcnt(3)
s_nop 0
v_mfma_f32_16x16x32_bf16 v[32:35], v[96:99], v[152:155], v[32:35]
s_waitcnt lgkmcnt(2)
v_mfma_f32_16x16x32_bf16 v[36:39], v[100:103], v[152:155], v[36:39]
v_sub_f32 v160, v160, v9
v_sub_f32 v161, v161, v9
v_sub_f32 v162, v162, v9
v_sub_f32 v163, v163, v9
v_sub_f32 v164, v164, v9
v_sub_f32 v165, v165, v9
v_sub_f32 v166, v166, v9
v_sub_f32 v167, v167, v9
v_exp_f32 v160, v160
v_exp_f32 v161, v161
v_exp_f32 v162, v162
v_exp_f32 v163, v163
v_exp_f32 v164, v164
v_exp_f32 v165, v165
v_exp_f32 v166, v166
v_exp_f32 v167, v167
v_cvt_pk_bf16_f32 v160, v160, v161
v_cvt_pk_bf16_f32 v161, v162, v163
v_cvt_pk_bf16_f32 v162, v164, v165
v_cvt_pk_bf16_f32 v163, v166, v167
s_waitcnt lgkmcnt(1)
s_nop 0
v_mfma_f32_16x16x32_bf16 v[32:35], v[40:43], v[160:163], v[32:35]
s_waitcnt lgkmcnt(0)
v_mfma_f32_16x16x32_bf16 v[36:39], v[44:47], v[160:163], v[36:39]
s_branch L36
L33:
ds_read_b128 v[176:179], v3 offset:14336
ds_read_b128 v[180:183], v3 offset:15360
ds_read_b128 v[184:187], v3 offset:16384
ds_read_b128 v[188:191], v3 offset:17408
s_waitcnt lgkmcnt(3)
v_mfma_f32_16x16x32_bf16 v[160:163], v[176:179], v[28:31], 0
ds_read_b128 v[208:211], v3 offset:38912
s_waitcnt lgkmcnt(3)
v_mfma_f32_16x16x32_bf16 v[164:167], v[180:183], v[28:31], 0
ds_read_b128 v[212:215], v3 offset:39936
s_waitcnt lgkmcnt(3)
v_mfma_f32_16x16x32_bf16 v[168:171], v[184:187], v[28:31], v[248:251]
ds_read_b128 v[216:219], v3 offset:40960
s_waitcnt lgkmcnt(3)
v_mfma_f32_16x16x32_bf16 v[172:175], v[188:191], v[28:31], v[252:255]
ds_read_b128 v[220:223], v3 offset:41984
v_max3_f32 v6, v160, v161, v162
v_max3_f32 v7, v163, v164, v165
v_max3_f32 v6, v6, v166, v167
s_nop 0
v_max3_f32 v7, v7, v168, v169
v_max3_f32 v6, v6, v170, v171
s_nop 0
v_max3_f32 v7, v7, v172, v173
v_max3_f32 v6, v6, v174, v175
v_max_f32 v6, v6, v7
v_mov_b32 v7, v6
s_nop 1
v_permlane32_swap_b32 v6, v7
v_max_f32 v6, v6, v7
v_mov_b32 v7, v6
s_nop 1
v_permlane16_swap_b32 v6, v7
v_max_f32 v10, v6, v7
v_sub_f32 v160, v160, v10
v_sub_f32 v161, v161, v10
v_sub_f32 v162, v162, v10
v_sub_f32 v163, v163, v10
v_sub_f32 v164, v164, v10
v_sub_f32 v165, v165, v10
v_sub_f32 v166, v166, v10
v_sub_f32 v167, v167, v10
v_exp_f32 v160, v160
v_exp_f32 v161, v161
v_exp_f32 v162, v162
v_exp_f32 v163, v163
v_exp_f32 v164, v164
v_exp_f32 v165, v165
v_exp_f32 v166, v166
v_exp_f32 v167, v167
v_cvt_pk_bf16_f32 v160, v160, v161
v_cvt_pk_bf16_f32 v161, v162, v163
v_cvt_pk_bf16_f32 v162, v164, v165
v_cvt_pk_bf16_f32 v163, v166, v167
s_waitcnt lgkmcnt(3)
s_nop 0
v_mfma_f32_16x16x32_bf16 v[32:35], v[208:211], v[160:163], 0
s_waitcnt lgkmcnt(2)
v_mfma_f32_16x16x32_bf16 v[36:39], v[212:215], v[160:163], 0
v_sub_f32 v168, v168, v10
v_sub_f32 v169, v169, v10
v_sub_f32 v170, v170, v10
v_sub_f32 v171, v171, v10
v_sub_f32 v172, v172, v10
v_sub_f32 v173, v173, v10
v_sub_f32 v174, v174, v10
v_sub_f32 v175, v175, v10
v_exp_f32 v168, v168
v_exp_f32 v169, v169
v_exp_f32 v170, v170
v_exp_f32 v171, v171
v_exp_f32 v172, v172
v_exp_f32 v173, v173
v_exp_f32 v174, v174
v_exp_f32 v175, v175
v_cvt_pk_bf16_f32 v168, v168, v169
v_cvt_pk_bf16_f32 v169, v170, v171
v_cvt_pk_bf16_f32 v170, v172, v173
v_cvt_pk_bf16_f32 v171, v174, v175
s_waitcnt lgkmcnt(1)
s_nop 0
v_mfma_f32_16x16x32_bf16 v[32:35], v[216:219], v[168:171], v[32:35]
s_waitcnt lgkmcnt(0)
v_mfma_f32_16x16x32_bf16 v[36:39], v[220:223], v[168:171], v[36:39]
s_lshr_b32 s4, s64, 2
s_and_b32 s5, s64, 3
s_add_u32 s6, s65, s4
s_lshl_b32 s7, s4, 4
s_add_u32 s7, s7, s67
s_sub_u32 s7, s7, 32
s_lshl_b32 s7, s7, 14
s_lshl_b32 s8, s5, 12
s_add_u32 s7, s7, s8
s_add_u32 s7, s7, 0x800000
s_cmp_lt_u32 s6, 2
s_cselect_b32 s7, 0x1700000, s7
s_lshl_b32 s8, s4, 13
s_and_b32 s9, s5, 1
s_lshl_b32 s9, s9, 12
s_add_u32 s8, s8, s9
s_cmp_ge_u32 s5, 2
s_cselect_b32 s9, 24576, 0
s_add_u32 m0, s8, s9
s_barrier
buffer_load_dwordx4 v1, s[52:55], s7 offen offset:0 sc1 lds
buffer_load_dwordx4 v1, s[52:55], s7 offen offset:1024 sc1 lds
buffer_load_dwordx4 v1, s[52:55], s7 offen offset:2048 sc1 lds
buffer_load_dwordx4 v1, s[52:55], s7 offen offset:3072 sc1 lds
s_waitcnt vmcnt(4)
s_cmp_eq_u32 s73, 0
s_cbranch_scc1 L44
s_lshl_b32 s6, s64, 12
s_add_u32 s6, s6, 86016
v_add_u32 v178, s6, v1
ds_write_b128 v178, v[56:59] offset:0
ds_write_b128 v178, v[60:63] offset:1024
ds_write_b128 v178, v[64:67] offset:2048
ds_write_b128 v178, v[68:71] offset:3072
v_lshlrev_b32 v178, 10, v14
v_lshrrev_b32 v179, 2, v15
v_lshl_add_u32 v178, v179, 7, v178
v_and_b32 v179, 3, v0
v_lshl_add_u32 v178, v179, 3, v178
v_add_u32 v178, s6, v178
ds_read_b64_tr_b16 v[72:73], v178 offset:0
ds_read_b64_tr_b16 v[74:75], v178 offset:512
ds_read_b64_tr_b16 v[76:77], v178 offset:32
ds_read_b64_tr_b16 v[78:79], v178 offset:544
ds_read_b64_tr_b16 v[80:81], v178 offset:64
ds_read_b64_tr_b16 v[82:83], v178 offset:576
ds_read_b64_tr_b16 v[84:85], v178 offset:96
ds_read_b64_tr_b16 v[86:87], v178 offset:608
s_waitcnt lgkmcnt(0)
L44:
s_waitcnt vmcnt(0)
s_barrier
ds_read_b32 v12, v11
ds_read_b128 v[40:43], v3 offset:0
ds_read_b128 v[44:47], v3 offset:1024
ds_read_b128 v[48:51], v3 offset:2048
ds_read_b128 v[52:55], v3 offset:3072
ds_read_b128 v[56:59], v3 offset:4096
ds_read_b128 v[60:63], v3 offset:5120
ds_read_b128 v[88:91], v3 offset:6144
ds_read_b128 v[92:95], v3 offset:7168
ds_read_b128 v[96:99], v3 offset:8192
ds_read_b128 v[100:103], v3 offset:9216
s_mov_b32 s4, s70
buffer_store_dwordx4 v[72:75], v1, s[52:55], s4 offen sc1
s_add_u32 s4, s4, s71
buffer_store_dwordx4 v[76:79], v1, s[52:55], s4 offen sc1
s_add_u32 s4, s4, s71
buffer_store_dwordx4 v[80:83], v1, s[52:55], s4 offen sc1
s_add_u32 s4, s4, s71
buffer_store_dwordx4 v[84:87], v1, s[52:55], s4 offen sc1
s_waitcnt lgkmcnt(10)
v_readfirstlane_b32 s68, v12
s_cmp_lg_u32 s64, 7
s_cselect_b32 s4, s68, 0
s_cmp_lg_u32 s4, 0
s_cselect_b32 s20, s17, 0x1800000
s_waitcnt lgkmcnt(9)
v_mfma_f32_16x16x32_bf16 v[104:107], v[40:43], v[28:31], v[240:243]
ds_read_b128 v[40:43], v3 offset:10240
s_waitcnt lgkmcnt(9)
v_mfma_f32_16x16x32_bf16 v[108:111], v[44:47], v[28:31], v[244:247]
ds_read_b128 v[44:47], v3 offset:11264
s_waitcnt lgkmcnt(9)
v_mfma_f32_16x16x32_bf16 v[112:115], v[48:51], v[28:31], 0
ds_read_b128 v[48:51], v3 offset:12288
s_waitcnt lgkmcnt(9)
v_mfma_f32_16x16x32_bf16 v[116:119], v[52:55], v[28:31], 0
ds_read_b128 v[52:55], v3 offset:13312
s_waitcnt lgkmcnt(9)
v_mfma_f32_16x16x32_bf16 v[120:123], v[56:59], v[28:31], 0
ds_read_b128 v[56:59], v3 offset:24576
s_waitcnt lgkmcnt(9)
v_mfma_f32_16x16x32_bf16 v[124:127], v[60:63], v[28:31], 0
ds_read_b128 v[60:63], v3 offset:25600
s_waitcnt lgkmcnt(9)
v_mfma_f32_16x16x32_bf16 v[128:131], v[88:91], v[28:31], 0
ds_read_b128 v[88:91], v3 offset:26624
s_waitcnt lgkmcnt(9)
v_mfma_f32_16x16x32_bf16 v[132:135], v[92:95], v[28:31], 0
ds_read_b128 v[92:95], v3 offset:27648
s_waitcnt lgkmcnt(9)
v_mfma_f32_16x16x32_bf16 v[136:139], v[96:99], v[28:31], 0
ds_read_b128 v[96:99], v3 offset:28672
s_waitcnt lgkmcnt(9)
v_mfma_f32_16x16x32_bf16 v[140:143], v[100:103], v[28:31], 0
ds_read_b128 v[100:103], v3 offset:29696
s_waitcnt lgkmcnt(9)
v_mfma_f32_16x16x32_bf16 v[144:147], v[40:43], v[28:31], 0
ds_read_b128 v[40:43], v3 offset:30720
s_waitcnt lgkmcnt(9)
v_mfma_f32_16x16x32_bf16 v[148:151], v[44:47], v[28:31], 0
ds_read_b128 v[44:47], v3 offset:31744
s_waitcnt lgkmcnt(9)
v_mfma_f32_16x16x32_bf16 v[152:155], v[48:51], v[28:31], 0
ds_read_b128 v[48:51], v3 offset:32768
s_waitcnt lgkmcnt(9)
v_mfma_f32_16x16x32_bf16 v[156:159], v[52:55], v[28:31], 0
ds_read_b128 v[52:55], v3 offset:33792
s_cmp_ge_u32 s65, 2
s_cbranch_scc1 L45
s_lshl_b32 s4, s65, 3
s_sub_u32 s4, 14, s4
s_cmp_gt_i32 s4, 0
s_cbranch_scc0 L45
v_mov_b32 v104, v5
v_mov_b32 v105, v5
v_mov_b32 v106, v5
v_mov_b32 v107, v5
s_cmp_gt_i32 s4, 1
s_cbranch_scc0 L45
v_mov_b32 v108, v5
v_mov_b32 v109, v5
v_mov_b32 v110, v5
v_mov_b32 v111, v5
s_cmp_gt_i32 s4, 2
s_cbranch_scc0 L45
v_mov_b32 v112, v5
v_mov_b32 v113, v5
v_mov_b32 v114, v5
v_mov_b32 v115, v5
s_cmp_gt_i32 s4, 3
s_cbranch_scc0 L45
v_mov_b32 v116, v5
v_mov_b32 v117, v5
v_mov_b32 v118, v5
v_mov_b32 v119, v5
s_cmp_gt_i32 s4, 4
s_cbranch_scc0 L45
v_mov_b32 v120, v5
v_mov_b32 v121, v5
v_mov_b32 v122, v5
v_mov_b32 v123, v5
s_cmp_gt_i32 s4, 5
s_cbranch_scc0 L45
v_mov_b32 v124, v5
v_mov_b32 v125, v5
v_mov_b32 v126, v5
v_mov_b32 v127, v5
s_cmp_gt_i32 s4, 6
s_cbranch_scc0 L45
v_mov_b32 v128, v5
v_mov_b32 v129, v5
v_mov_b32 v130, v5
v_mov_b32 v131, v5
s_cmp_gt_i32 s4, 7
s_cbranch_scc0 L45
v_mov_b32 v132, v5
v_mov_b32 v133, v5
v_mov_b32 v134, v5
v_mov_b32 v135, v5
s_cmp_gt_i32 s4, 8
s_cbranch_scc0 L45
v_mov_b32 v136, v5
v_mov_b32 v137, v5
v_mov_b32 v138, v5
v_mov_b32 v139, v5
s_cmp_gt_i32 s4, 9
s_cbranch_scc0 L45
v_mov_b32 v140, v5
v_mov_b32 v141, v5
v_mov_b32 v142, v5
v_mov_b32 v143, v5
s_cmp_gt_i32 s4, 10
s_cbranch_scc0 L45
v_mov_b32 v144, v5
v_mov_b32 v145, v5
v_mov_b32 v146, v5
v_mov_b32 v147, v5
s_cmp_gt_i32 s4, 11
s_cbranch_scc0 L45
v_mov_b32 v148, v5
v_mov_b32 v149, v5
v_mov_b32 v150, v5
v_mov_b32 v151, v5
s_cmp_gt_i32 s4, 12
s_cbranch_scc0 L45
v_mov_b32 v152, v5
v_mov_b32 v153, v5
v_mov_b32 v154, v5
v_mov_b32 v155, v5
s_cmp_gt_i32 s4, 13
s_cbranch_scc0 L45
v_mov_b32 v156, v5
v_mov_b32 v157, v5
v_mov_b32 v158, v5
v_mov_b32 v159, v5
L45:
v_max3_f32 v6, v104, v105, v106
v_max3_f32 v7, v107, v108, v109
v_max3_f32 v6, v6, v110, v111
v_max3_f32 v7, v7, v112, v113
v_max3_f32 v6, v6, v114, v115
v_max3_f32 v7, v7, v116, v117
v_max3_f32 v6, v6, v118, v119
v_max3_f32 v7, v7, v120, v121
v_max3_f32 v6, v6, v122, v123
v_max3_f32 v7, v7, v124, v125
v_max3_f32 v6, v6, v126, v127
v_max3_f32 v7, v7, v128, v129
v_max3_f32 v6, v6, v130, v131
v_max3_f32 v7, v7, v132, v133
v_max3_f32 v6, v6, v134, v135
v_max3_f32 v7, v7, v136, v137
v_max3_f32 v6, v6, v138, v139
v_max3_f32 v7, v7, v140, v141
v_max3_f32 v6, v6, v142, v143
v_max3_f32 v7, v7, v144, v145
v_max3_f32 v6, v6, v146, v147
v_max3_f32 v7, v7, v148, v149
v_max3_f32 v6, v6, v150, v151
v_max3_f32 v7, v7, v152, v153
v_max3_f32 v6, v6, v154, v155
v_max3_f32 v7, v7, v156, v157
v_max3_f32 v6, v6, v158, v159
v_max_f32 v7, v7, v10
v_max_f32 v6, v6, v7
v_mov_b32 v7, v6
s_nop 1
v_permlane32_swap_b32 v6, v7
v_max_f32 v6, v6, v7
v_mov_b32 v7, v6
s_nop 1
v_permlane16_swap_b32 v6, v7
v_max_f32 v9, v6, v7
v_sub_f32 v7, v10, v9
v_exp_f32 v7, v7
s_waitcnt vmcnt(0)
s_waitcnt lgkmcnt(0)
v_mov_b32 v12, 1
s_mov_b64 exec, 1
ds_add_rtn_u32 v12, v11, v12 offset:16
s_waitcnt lgkmcnt(0)
v_readfirstlane_b32 s5, v12
s_nop 0
s_cmp_lg_u32 s5, 7
s_cbranch_scc1 L46
s_lshl_b32 s4, s67, 3
s_add_u32 s4, s4, 0x22000
buffer_store_dwordx2 v[24:25], v1, s[52:55], s4 offen sc1
L46:
s_mov_b64 exec, -1
v_mul_f32 v32, v32, v7
v_mul_f32 v33, v33, v7
v_mul_f32 v34, v34, v7
v_mul_f32 v35, v35, v7
v_mul_f32 v36, v36, v7
v_mul_f32 v37, v37, v7
v_mul_f32 v38, v38, v7
v_mul_f32 v39, v39, v7
v_sub_f32 v104, v104, v9
v_sub_f32 v105, v105, v9
v_sub_f32 v106, v106, v9
v_sub_f32 v107, v107, v9
v_sub_f32 v108, v108, v9
v_sub_f32 v109, v109, v9
v_sub_f32 v110, v110, v9
v_sub_f32 v111, v111, v9
v_exp_f32 v104, v104
v_exp_f32 v105, v105
buffer_load_dwordx4 v[176:179], v1, s[52:55], s20 offen offset:0 sc1
v_exp_f32 v106, v106
v_exp_f32 v107, v107
buffer_load_dwordx4 v[180:183], v1, s[52:55], s20 offen offset:1024 sc1
v_exp_f32 v108, v108
v_exp_f32 v109, v109
buffer_load_dwordx4 v[184:187], v1, s[52:55], s20 offen offset:2048 sc1
v_exp_f32 v110, v110
v_exp_f32 v111, v111
v_cvt_pk_bf16_f32 v104, v104, v105
v_cvt_pk_bf16_f32 v105, v106, v107
v_cvt_pk_bf16_f32 v106, v108, v109
v_cvt_pk_bf16_f32 v107, v110, v111
s_nop 1
v_mfma_f32_16x16x32_bf16 v[32:35], v[56:59], v[104:107], v[32:35]
ds_read_b128 v[56:59], v3 offset:34816
v_mfma_f32_16x16x32_bf16 v[36:39], v[60:63], v[104:107], v[36:39]
ds_read_b128 v[60:63], v3 offset:35840
v_sub_f32 v112, v112, v9
v_sub_f32 v113, v113, v9
v_sub_f32 v114, v114, v9
v_sub_f32 v115, v115, v9
v_sub_f32 v116, v116, v9
v_sub_f32 v117, v117, v9
v_sub_f32 v118, v118, v9
v_sub_f32 v119, v119, v9
v_exp_f32 v112, v112
v_exp_f32 v113, v113
buffer_load_dwordx4 v[188:191], v1, s[52:55], s20 offen offset:3072 sc1
v_exp_f32 v114, v114
v_exp_f32 v115, v115
s_add_u32 s9, s20, 4096
buffer_load_dwordx4 v[192:195], v1, s[52:55], s9 offen offset:0 sc1
v_exp_f32 v116, v116
v_exp_f32 v117, v117
s_add_u32 s9, s20, 4096
buffer_load_dwordx4 v[196:199], v1, s[52:55], s9 offen offset:1024 sc1
v_exp_f32 v118, v118
v_exp_f32 v119, v119
v_cvt_pk_bf16_f32 v112, v112, v113
v_cvt_pk_bf16_f32 v113, v114, v115
v_cvt_pk_bf16_f32 v114, v116, v117
v_cvt_pk_bf16_f32 v115, v118, v119
s_nop 1
v_mfma_f32_16x16x32_bf16 v[32:35], v[88:91], v[112:115], v[32:35]
ds_read_b128 v[88:91], v3 offset:36864
v_mfma_f32_16x16x32_bf16 v[36:39], v[92:95], v[112:115], v[36:39]
ds_read_b128 v[92:95], v3 offset:37888
v_sub_f32 v120, v120, v9
v_sub_f32 v121, v121, v9
v_sub_f32 v122, v122, v9
v_sub_f32 v123, v123, v9
v_sub_f32 v124, v124, v9
v_sub_f32 v125, v125, v9
v_sub_f32 v126, v126, v9
v_sub_f32 v127, v127, v9
v_exp_f32 v120, v120
v_exp_f32 v121, v121
s_add_u32 s9, s20, 4096
buffer_load_dwordx4 v[200:203], v1, s[52:55], s9 offen offset:2048 sc1
v_exp_f32 v122, v122
v_exp_f32 v123, v123
s_add_u32 s9, s20, 4096
buffer_load_dwordx4 v[204:207], v1, s[52:55], s9 offen offset:3072 sc1
v_exp_f32 v124, v124
v_exp_f32 v125, v125
s_add_u32 s9, s20, 8192
buffer_load_dwordx4 v[208:211], v1, s[52:55], s9 offen offset:0 sc1
v_exp_f32 v126, v126
v_exp_f32 v127, v127
v_cvt_pk_bf16_f32 v120, v120, v121
v_cvt_pk_bf16_f32 v121, v122, v123
v_cvt_pk_bf16_f32 v122, v124, v125
v_cvt_pk_bf16_f32 v123, v126, v127
s_nop 1
v_mfma_f32_16x16x32_bf16 v[32:35], v[96:99], v[120:123], v[32:35]
v_mfma_f32_16x16x32_bf16 v[36:39], v[100:103], v[120:123], v[36:39]
v_sub_f32 v128, v128, v9
v_sub_f32 v129, v129, v9
v_sub_f32 v130, v130, v9
v_sub_f32 v131, v131, v9
v_sub_f32 v132, v132, v9
v_sub_f32 v133, v133, v9
v_sub_f32 v134, v134, v9
v_sub_f32 v135, v135, v9
v_exp_f32 v128, v128
v_exp_f32 v129, v129
s_add_u32 s9, s20, 8192
buffer_load_dwordx4 v[212:215], v1, s[52:55], s9 offen offset:1024 sc1
v_exp_f32 v130, v130
v_exp_f32 v131, v131
s_add_u32 s9, s20, 8192
buffer_load_dwordx4 v[216:219], v1, s[52:55], s9 offen offset:2048 sc1
v_exp_f32 v132, v132
v_exp_f32 v133, v133
s_add_u32 s9, s20, 8192
buffer_load_dwordx4 v[220:223], v1, s[52:55], s9 offen offset:3072 sc1
v_exp_f32 v134, v134
v_exp_f32 v135, v135
v_cvt_pk_bf16_f32 v128, v128, v129
v_cvt_pk_bf16_f32 v129, v130, v131
v_cvt_pk_bf16_f32 v130, v132, v133
v_cvt_pk_bf16_f32 v131, v134, v135
s_nop 1
v_mfma_f32_16x16x32_bf16 v[32:35], v[40:43], v[128:131], v[32:35]
v_mfma_f32_16x16x32_bf16 v[36:39], v[44:47], v[128:131], v[36:39]
v_sub_f32 v136, v136, v9
v_sub_f32 v137, v137, v9
v_sub_f32 v138, v138, v9
v_sub_f32 v139, v139, v9
v_sub_f32 v140, v140, v9
v_sub_f32 v141, v141, v9
v_sub_f32 v142, v142, v9
v_sub_f32 v143, v143, v9
v_exp_f32 v136, v136
v_exp_f32 v137, v137
s_add_u32 s9, s20, 12288
buffer_load_dwordx4 v[224:227], v1, s[52:55], s9 offen offset:0 sc1
v_exp_f32 v138, v138
v_exp_f32 v139, v139
s_add_u32 s9, s20, 12288
buffer_load_dwordx4 v[228:231], v1, s[52:55], s9 offen offset:1024 sc1
v_exp_f32 v140, v140
v_exp_f32 v141, v141
s_add_u32 s9, s20, 12288
buffer_load_dwordx4 v[232:235], v1, s[52:55], s9 offen offset:2048 sc1
v_exp_f32 v142, v142
v_exp_f32 v143, v143
v_cvt_pk_bf16_f32 v136, v136, v137
v_cvt_pk_bf16_f32 v137, v138, v139
v_cvt_pk_bf16_f32 v138, v140, v141
v_cvt_pk_bf16_f32 v139, v142, v143
s_nop 1
v_mfma_f32_16x16x32_bf16 v[32:35], v[48:51], v[136:139], v[32:35]
v_mfma_f32_16x16x32_bf16 v[36:39], v[52:55], v[136:139], v[36:39]
v_sub_f32 v144, v144, v9
v_sub_f32 v145, v145, v9
v_sub_f32 v146, v146, v9
v_sub_f32 v147, v147, v9
v_sub_f32 v148, v148, v9
v_sub_f32 v149, v149, v9
v_sub_f32 v150, v150, v9
v_sub_f32 v151, v151, v9
v_exp_f32 v144, v144
v_exp_f32 v145, v145
s_add_u32 s9, s20, 12288
buffer_load_dwordx4 v[236:239], v1, s[52:55], s9 offen offset:3072 sc1
v_exp_f32 v146, v146
v_exp_f32 v147, v147
v_exp_f32 v148, v148
v_exp_f32 v149, v149
v_exp_f32 v150, v150
v_exp_f32 v151, v151
v_cvt_pk_bf16_f32 v144, v144, v145
v_cvt_pk_bf16_f32 v145, v146, v147
v_cvt_pk_bf16_f32 v146, v148, v149
v_cvt_pk_bf16_f32 v147, v150, v151
s_waitcnt lgkmcnt(3)
s_nop 0
v_mfma_f32_16x16x32_bf16 v[32:35], v[56:59], v[144:147], v[32:35]
s_waitcnt lgkmcnt(2)
v_mfma_f32_16x16x32_bf16 v[36:39], v[60:63], v[144:147], v[36:39]
v_sub_f32 v152, v152, v9
v_sub_f32 v153, v153, v9
v_sub_f32 v154, v154, v9
v_sub_f32 v155, v155, v9
v_sub_f32 v156, v156, v9
v_sub_f32 v157, v157, v9
v_sub_f32 v158, v158, v9
v_sub_f32 v159, v159, v9
v_exp_f32 v152, v152
v_exp_f32 v153, v153
v_exp_f32 v154, v154
v_exp_f32 v155, v155
v_exp_f32 v156, v156
v_exp_f32 v157, v157
v_exp_f32 v158, v158
v_exp_f32 v159, v159
v_cvt_pk_bf16_f32 v152, v152, v153
v_cvt_pk_bf16_f32 v153, v154, v155
v_cvt_pk_bf16_f32 v154, v156, v157
v_cvt_pk_bf16_f32 v155, v158, v159
s_waitcnt lgkmcnt(1)
s_nop 0
v_mfma_f32_16x16x32_bf16 v[32:35], v[88:91], v[152:155], v[32:35]
s_waitcnt lgkmcnt(0)
v_mfma_f32_16x16x32_bf16 v[36:39], v[92:95], v[152:155], v[36:39]
s_branch L36
L34:
ds_read_b128 v[176:179], v3 offset:12288
ds_read_b128 v[180:183], v3 offset:13312
ds_read_b128 v[184:187], v3 offset:14336
ds_read_b128 v[188:191], v3 offset:15360
ds_read_b128 v[192:195], v3 offset:16384
ds_read_b128 v[196:199], v3 offset:17408
s_waitcnt lgkmcnt(5)
v_mfma_f32_16x16x32_bf16 v[152:155], v[176:179], v[28:31], 0
ds_read_b128 v[208:211], v3 offset:36864
s_waitcnt lgkmcnt(5)
v_mfma_f32_16x16x32_bf16 v[156:159], v[180:183], v[28:31], 0
ds_read_b128 v[212:215], v3 offset:37888
s_waitcnt lgkmcnt(5)
v_mfma_f32_16x16x32_bf16 v[160:163], v[184:187], v[28:31], 0
ds_read_b128 v[216:219], v3 offset:38912
s_waitcnt lgkmcnt(5)
v_mfma_f32_16x16x32_bf16 v[164:167], v[188:191], v[28:31], 0
ds_read_b128 v[220:223], v3 offset:39936
s_waitcnt lgkmcnt(5)
v_mfma_f32_16x16x32_bf16 v[168:171], v[192:195], v[28:31], v[248:251]
ds_read_b128 v[224:227], v3 offset:40960
s_waitcnt lgkmcnt(5)
v_mfma_f32_16x16x32_bf16 v[172:175], v[196:199], v[28:31], v[252:255]
ds_read_b128 v[228:231], v3 offset:41984
v_max3_f32 v6, v152, v153, v154
v_max3_f32 v7, v155, v156, v157
v_max3_f32 v6, v6, v158, v159
v_max3_f32 v7, v7, v160, v161
v_max3_f32 v6, v6, v162, v163
v_max3_f32 v7, v7, v164, v165
v_max3_f32 v6, v6, v166, v167
v_max3_f32 v7, v7, v168, v169
v_max3_f32 v6, v6, v170, v171
v_max3_f32 v7, v7, v172, v173
v_max3_f32 v6, v6, v174, v175
v_max_f32 v6, v6, v7
v_mov_b32 v7, v6
s_nop 1
v_permlane32_swap_b32 v6, v7
v_max_f32 v6, v6, v7
v_mov_b32 v7, v6
s_nop 1
v_permlane16_swap_b32 v6, v7
v_max_f32 v10, v6, v7
v_sub_f32 v152, v152, v10
v_sub_f32 v153, v153, v10
v_sub_f32 v154, v154, v10
v_sub_f32 v155, v155, v10
v_sub_f32 v156, v156, v10
v_sub_f32 v157, v157, v10
v_sub_f32 v158, v158, v10
v_sub_f32 v159, v159, v10
v_exp_f32 v152, v152
v_exp_f32 v153, v153
v_exp_f32 v154, v154
v_exp_f32 v155, v155
v_exp_f32 v156, v156
v_exp_f32 v157, v157
v_exp_f32 v158, v158
v_exp_f32 v159, v159
v_cvt_pk_bf16_f32 v152, v152, v153
v_cvt_pk_bf16_f32 v153, v154, v155
v_cvt_pk_bf16_f32 v154, v156, v157
v_cvt_pk_bf16_f32 v155, v158, v159
s_waitcnt lgkmcnt(5)
s_nop 0
v_mfma_f32_16x16x32_bf16 v[32:35], v[208:211], v[152:155], 0
s_waitcnt lgkmcnt(4)
v_mfma_f32_16x16x32_bf16 v[36:39], v[212:215], v[152:155], 0
v_sub_f32 v160, v160, v10
v_sub_f32 v161, v161, v10
v_sub_f32 v162, v162, v10
v_sub_f32 v163, v163, v10
v_sub_f32 v164, v164, v10
v_sub_f32 v165, v165, v10
v_sub_f32 v166, v166, v10
v_sub_f32 v167, v167, v10
v_exp_f32 v160, v160
v_exp_f32 v161, v161
v_exp_f32 v162, v162
v_exp_f32 v163, v163
v_exp_f32 v164, v164
v_exp_f32 v165, v165
v_exp_f32 v166, v166
v_exp_f32 v167, v167
v_cvt_pk_bf16_f32 v160, v160, v161
v_cvt_pk_bf16_f32 v161, v162, v163
v_cvt_pk_bf16_f32 v162, v164, v165
v_cvt_pk_bf16_f32 v163, v166, v167
s_waitcnt lgkmcnt(3)
s_nop 0
v_mfma_f32_16x16x32_bf16 v[32:35], v[216:219], v[160:163], v[32:35]
s_waitcnt lgkmcnt(2)
v_mfma_f32_16x16x32_bf16 v[36:39], v[220:223], v[160:163], v[36:39]
v_sub_f32 v168, v168, v10
v_sub_f32 v169, v169, v10
v_sub_f32 v170, v170, v10
v_sub_f32 v171, v171, v10
v_sub_f32 v172, v172, v10
v_sub_f32 v173, v173, v10
v_sub_f32 v174, v174, v10
v_sub_f32 v175, v175, v10
v_exp_f32 v168, v168
v_exp_f32 v169, v169
v_exp_f32 v170, v170
v_exp_f32 v171, v171
v_exp_f32 v172, v172
v_exp_f32 v173, v173
v_exp_f32 v174, v174
v_exp_f32 v175, v175
v_cvt_pk_bf16_f32 v168, v168, v169
v_cvt_pk_bf16_f32 v169, v170, v171
v_cvt_pk_bf16_f32 v170, v172, v173
v_cvt_pk_bf16_f32 v171, v174, v175
s_waitcnt lgkmcnt(1)
s_nop 0
v_mfma_f32_16x16x32_bf16 v[32:35], v[224:227], v[168:171], v[32:35]
s_waitcnt lgkmcnt(0)
v_mfma_f32_16x16x32_bf16 v[36:39], v[228:231], v[168:171], v[36:39]
s_lshr_b32 s4, s64, 2
s_and_b32 s5, s64, 3
s_add_u32 s6, s65, s4
s_lshl_b32 s7, s4, 4
s_add_u32 s7, s7, s67
s_sub_u32 s7, s7, 32
s_lshl_b32 s7, s7, 14
s_lshl_b32 s8, s5, 12
s_add_u32 s7, s7, s8
s_add_u32 s7, s7, 0x800000
s_cmp_lt_u32 s6, 2
s_cselect_b32 s7, 0x1700000, s7
s_lshl_b32 s8, s4, 13
s_and_b32 s9, s5, 1
s_lshl_b32 s9, s9, 12
s_add_u32 s8, s8, s9
s_cmp_ge_u32 s5, 2
s_cselect_b32 s9, 24576, 0
s_add_u32 m0, s8, s9
s_barrier
buffer_load_dwordx4 v1, s[52:55], s7 offen offset:0 sc1 lds
buffer_load_dwordx4 v1, s[52:55], s7 offen offset:1024 sc1 lds
buffer_load_dwordx4 v1, s[52:55], s7 offen offset:2048 sc1 lds
buffer_load_dwordx4 v1, s[52:55], s7 offen offset:3072 sc1 lds
s_waitcnt vmcnt(4)
s_cmp_eq_u32 s73, 0
s_cbranch_scc1 L47
s_lshl_b32 s6, s64, 12
s_add_u32 s6, s6, 86016
v_add_u32 v178, s6, v1
ds_write_b128 v178, v[56:59] offset:0
ds_write_b128 v178, v[60:63] offset:1024
ds_write_b128 v178, v[64:67] offset:2048
ds_write_b128 v178, v[68:71] offset:3072
v_lshlrev_b32 v178, 10, v14
v_lshrrev_b32 v179, 2, v15
v_lshl_add_u32 v178, v179, 7, v178
v_and_b32 v179, 3, v0
v_lshl_add_u32 v178, v179, 3, v178
v_add_u32 v178, s6, v178
ds_read_b64_tr_b16 v[72:73], v178 offset:0
ds_read_b64_tr_b16 v[74:75], v178 offset:512
ds_read_b64_tr_b16 v[76:77], v178 offset:32
ds_read_b64_tr_b16 v[78:79], v178 offset:544
ds_read_b64_tr_b16 v[80:81], v178 offset:64
ds_read_b64_tr_b16 v[82:83], v178 offset:576
ds_read_b64_tr_b16 v[84:85], v178 offset:96
ds_read_b64_tr_b16 v[86:87], v178 offset:608
s_waitcnt lgkmcnt(0)
L47:
s_waitcnt vmcnt(0)
s_barrier
ds_read_b32 v12, v11
ds_read_b128 v[40:43], v3 offset:0
ds_read_b128 v[44:47], v3 offset:1024
ds_read_b128 v[48:51], v3 offset:2048
ds_read_b128 v[52:55], v3 offset:3072
ds_read_b128 v[56:59], v3 offset:4096
ds_read_b128 v[60:63], v3 offset:5120
ds_read_b128 v[88:91], v3 offset:6144
ds_read_b128 v[92:95], v3 offset:7168
ds_read_b128 v[96:99], v3 offset:8192
ds_read_b128 v[100:103], v3 offset:9216
s_mov_b32 s4, s70
buffer_store_dwordx4 v[72:75], v1, s[52:55], s4 offen sc1
s_add_u32 s4, s4, s71
buffer_store_dwordx4 v[76:79], v1, s[52:55], s4 offen sc1
s_add_u32 s4, s4, s71
buffer_store_dwordx4 v[80:83], v1, s[52:55], s4 offen sc1
s_add_u32 s4, s4, s71
buffer_store_dwordx4 v[84:87], v1, s[52:55], s4 offen sc1
s_waitcnt lgkmcnt(10)
v_readfirstlane_b32 s68, v12
s_cmp_lg_u32 s64, 7
s_cselect_b32 s4, s68, 0
s_cmp_lg_u32 s4, 0
s_cselect_b32 s20, s17, 0x1800000
s_waitcnt lgkmcnt(9)
v_mfma_f32_16x16x32_bf16 v[104:107], v[40:43], v[28:31], v[240:243]
ds_read_b128 v[40:43], v3 offset:10240
s_waitcnt lgkmcnt(9)
v_mfma_f32_16x16x32_bf16 v[108:111], v[44:47], v[28:31], v[244:247]
ds_read_b128 v[44:47], v3 offset:11264
s_waitcnt lgkmcnt(9)
v_mfma_f32_16x16x32_bf16 v[112:115], v[48:51], v[28:31], 0
ds_read_b128 v[48:51], v3 offset:24576
s_waitcnt lgkmcnt(9)
v_mfma_f32_16x16x32_bf16 v[116:119], v[52:55], v[28:31], 0
ds_read_b128 v[52:55], v3 offset:25600
s_waitcnt lgkmcnt(9)
v_mfma_f32_16x16x32_bf16 v[120:123], v[56:59], v[28:31], 0
ds_read_b128 v[56:59], v3 offset:26624
s_waitcnt lgkmcnt(9)
v_mfma_f32_16x16x32_bf16 v[124:127], v[60:63], v[28:31], 0
ds_read_b128 v[60:63], v3 offset:27648
s_waitcnt lgkmcnt(9)
v_mfma_f32_16x16x32_bf16 v[128:131], v[88:91], v[28:31], 0
ds_read_b128 v[88:91], v3 offset:28672
s_waitcnt lgkmcnt(9)
v_mfma_f32_16x16x32_bf16 v[132:135], v[92:95], v[28:31], 0
ds_read_b128 v[92:95], v3 offset:29696
s_waitcnt lgkmcnt(9)
v_mfma_f32_16x16x32_bf16 v[136:139], v[96:99], v[28:31], 0
ds_read_b128 v[96:99], v3 offset:30720
s_waitcnt lgkmcnt(9)
v_mfma_f32_16x16x32_bf16 v[140:143], v[100:103], v[28:31], 0
ds_read_b128 v[100:103], v3 offset:31744
s_waitcnt lgkmcnt(9)
v_mfma_f32_16x16x32_bf16 v[144:147], v[40:43], v[28:31], 0
ds_read_b128 v[40:43], v3 offset:32768
s_waitcnt lgkmcnt(9)
v_mfma_f32_16x16x32_bf16 v[148:151], v[44:47], v[28:31], 0
ds_read_b128 v[44:47], v3 offset:33792
s_cmp_ge_u32 s65, 2
s_cbranch_scc1 L48
s_lshl_b32 s4, s65, 3
s_sub_u32 s4, 12, s4
s_cmp_gt_i32 s4, 0
s_cbranch_scc0 L48
v_mov_b32 v104, v5
v_mov_b32 v105, v5
v_mov_b32 v106, v5
v_mov_b32 v107, v5
s_cmp_gt_i32 s4, 1
s_cbranch_scc0 L48
v_mov_b32 v108, v5
v_mov_b32 v109, v5
v_mov_b32 v110, v5
v_mov_b32 v111, v5
s_cmp_gt_i32 s4, 2
s_cbranch_scc0 L48
v_mov_b32 v112, v5
v_mov_b32 v113, v5
v_mov_b32 v114, v5
v_mov_b32 v115, v5
s_cmp_gt_i32 s4, 3
s_cbranch_scc0 L48
v_mov_b32 v116, v5
v_mov_b32 v117, v5
v_mov_b32 v118, v5
v_mov_b32 v119, v5
s_cmp_gt_i32 s4, 4
s_cbranch_scc0 L48
v_mov_b32 v120, v5
v_mov_b32 v121, v5
v_mov_b32 v122, v5
v_mov_b32 v123, v5
s_cmp_gt_i32 s4, 5
s_cbranch_scc0 L48
v_mov_b32 v124, v5
v_mov_b32 v125, v5
v_mov_b32 v126, v5
v_mov_b32 v127, v5
s_cmp_gt_i32 s4, 6
s_cbranch_scc0 L48
v_mov_b32 v128, v5
v_mov_b32 v129, v5
v_mov_b32 v130, v5
v_mov_b32 v131, v5
s_cmp_gt_i32 s4, 7
s_cbranch_scc0 L48
v_mov_b32 v132, v5
v_mov_b32 v133, v5
v_mov_b32 v134, v5
v_mov_b32 v135, v5
s_cmp_gt_i32 s4, 8
s_cbranch_scc0 L48
v_mov_b32 v136, v5
v_mov_b32 v137, v5
v_mov_b32 v138, v5
v_mov_b32 v139, v5
s_cmp_gt_i32 s4, 9
s_cbranch_scc0 L48
v_mov_b32 v140, v5
v_mov_b32 v141, v5
v_mov_b32 v142, v5
v_mov_b32 v143, v5
s_cmp_gt_i32 s4, 10
s_cbranch_scc0 L48
v_mov_b32 v144, v5
v_mov_b32 v145, v5
v_mov_b32 v146, v5
v_mov_b32 v147, v5
s_cmp_gt_i32 s4, 11
s_cbranch_scc0 L48
v_mov_b32 v148, v5
v_mov_b32 v149, v5
v_mov_b32 v150, v5
v_mov_b32 v151, v5
L48:
v_max3_f32 v6, v104, v105, v106
v_max3_f32 v7, v107, v108, v109
v_max3_f32 v6, v6, v110, v111
v_max3_f32 v7, v7, v112, v113
v_max3_f32 v6, v6, v114, v115
v_max3_f32 v7, v7, v116, v117
v_max3_f32 v6, v6, v118, v119
v_max3_f32 v7, v7, v120, v121
v_max3_f32 v6, v6, v122, v123
v_max3_f32 v7, v7, v124, v125
v_max3_f32 v6, v6, v126, v127
v_max3_f32 v7, v7, v128, v129
v_max3_f32 v6, v6, v130, v131
v_max3_f32 v7, v7, v132, v133
v_max3_f32 v6, v6, v134, v135
v_max3_f32 v7, v7, v136, v137
v_max3_f32 v6, v6, v138, v139
v_max3_f32 v7, v7, v140, v141
v_max3_f32 v6, v6, v142, v143
v_max3_f32 v7, v7, v144, v145
v_max3_f32 v6, v6, v146, v147
v_max3_f32 v7, v7, v148, v149
v_max3_f32 v6, v6, v150, v151
v_max_f32 v7, v7, v10
v_max_f32 v6, v6, v7
v_mov_b32 v7, v6
s_nop 1
v_permlane32_swap_b32 v6, v7
v_max_f32 v6, v6, v7
v_mov_b32 v7, v6
s_nop 1
v_permlane16_swap_b32 v6, v7
v_max_f32 v9, v6, v7
v_sub_f32 v7, v10, v9
v_exp_f32 v7, v7
s_waitcnt vmcnt(0)
s_waitcnt lgkmcnt(0)
v_mov_b32 v12, 1
s_mov_b64 exec, 1
ds_add_rtn_u32 v12, v11, v12 offset:16
s_waitcnt lgkmcnt(0)
v_readfirstlane_b32 s5, v12
s_nop 0
s_cmp_lg_u32 s5, 7
s_cbranch_scc1 L49
s_lshl_b32 s4, s67, 3
s_add_u32 s4, s4, 0x22000
buffer_store_dwordx2 v[24:25], v1, s[52:55], s4 offen sc1
L49:
s_mov_b64 exec, -1
v_mul_f32 v32, v32, v7
v_mul_f32 v33, v33, v7
v_mul_f32 v34, v34, v7
v_mul_f32 v35, v35, v7
v_mul_f32 v36, v36, v7
v_mul_f32 v37, v37, v7
v_mul_f32 v38, v38, v7
v_mul_f32 v39, v39, v7
v_sub_f32 v104, v104, v9
v_sub_f32 v105, v105, v9
v_sub_f32 v106, v106, v9
v_sub_f32 v107, v107, v9
v_sub_f32 v108, v108, v9
v_sub_f32 v109, v109, v9
v_sub_f32 v110, v110, v9
v_sub_f32 v111, v111, v9
v_exp_f32 v104, v104
v_exp_f32 v105, v105
buffer_load_dwordx4 v[176:179], v1, s[52:55], s20 offen offset:0 sc1
v_exp_f32 v106, v106
v_exp_f32 v107, v107
buffer_load_dwordx4 v[180:183], v1, s[52:55], s20 offen offset:1024 sc1
v_exp_f32 v108, v108
v_exp_f32 v109, v109
buffer_load_dwordx4 v[184:187], v1, s[52:55], s20 offen offset:2048 sc1
v_exp_f32 v110, v110
v_exp_f32 v111, v111
buffer_load_dwordx4 v[188:191], v1, s[52:55], s20 offen offset:3072 sc1
v_cvt_pk_bf16_f32 v104, v104, v105
v_cvt_pk_bf16_f32 v105, v106, v107
v_cvt_pk_bf16_f32 v106, v108, v109
v_cvt_pk_bf16_f32 v107, v110, v111
s_nop 1
v_mfma_f32_16x16x32_bf16 v[32:35], v[48:51], v[104:107], v[32:35]
ds_read_b128 v[48:51], v3 offset:34816
v_mfma_f32_16x16x32_bf16 v[36:39], v[52:55], v[104:107], v[36:39]
ds_read_b128 v[52:55], v3 offset:35840
v_sub_f32 v112, v112, v9
v_sub_f32 v113, v113, v9
v_sub_f32 v114, v114, v9
v_sub_f32 v115, v115, v9
v_sub_f32 v116, v116, v9
v_sub_f32 v117, v117, v9
v_sub_f32 v118, v118, v9
v_sub_f32 v119, v119, v9
v_exp_f32 v112, v112
v_exp_f32 v113, v113
s_add_u32 s9, s20, 4096
buffer_load_dwordx4 v[192:195], v1, s[52:55], s9 offen offset:0 sc1
v_exp_f32 v114, v114
v_exp_f32 v115, v115
s_add_u32 s9, s20, 4096
buffer_load_dwordx4 v[196:199], v1, s[52:55], s9 offen offset:1024 sc1
v_exp_f32 v116, v116
v_exp_f32 v117, v117
s_add_u32 s9, s20, 4096
buffer_load_dwordx4 v[200:203], v1, s[52:55], s9 offen offset:2048 sc1
v_exp_f32 v118, v118
v_exp_f32 v119, v119
s_add_u32 s9, s20, 4096
buffer_load_dwordx4 v[204:207], v1, s[52:55], s9 offen offset:3072 sc1
v_cvt_pk_bf16_f32 v112, v112, v113
v_cvt_pk_bf16_f32 v113, v114, v115
v_cvt_pk_bf16_f32 v114, v116, v117
v_cvt_pk_bf16_f32 v115, v118, v119
s_nop 1
v_mfma_f32_16x16x32_bf16 v[32:35], v[56:59], v[112:115], v[32:35]
v_mfma_f32_16x16x32_bf16 v[36:39], v[60:63], v[112:115], v[36:39]
v_sub_f32 v120, v120, v9
v_sub_f32 v121, v121, v9
v_sub_f32 v122, v122, v9
v_sub_f32 v123, v123, v9
v_sub_f32 v124, v124, v9
v_sub_f32 v125, v125, v9
v_sub_f32 v126, v126, v9
v_sub_f32 v127, v127, v9
v_exp_f32 v120, v120
v_exp_f32 v121, v121
s_add_u32 s9, s20, 8192
buffer_load_dwordx4 v[208:211], v1, s[52:55], s9 offen offset:0 sc1
v_exp_f32 v122, v122
v_exp_f32 v123, v123
s_add_u32 s9, s20, 8192
buffer_load_dwordx4 v[212:215], v1, s[52:55], s9 offen offset:1024 sc1
v_exp_f32 v124, v124
v_exp_f32 v125, v125
s_add_u32 s9, s20, 8192
buffer_load_dwordx4 v[216:219], v1, s[52:55], s9 offen offset:2048 sc1
v_exp_f32 v126, v126
v_exp_f32 v127, v127
s_add_u32 s9, s20, 8192
buffer_load_dwordx4 v[220:223], v1, s[52:55], s9 offen offset:3072 sc1
v_cvt_pk_bf16_f32 v120, v120, v121
v_cvt_pk_bf16_f32 v121, v122, v123
v_cvt_pk_bf16_f32 v122, v124, v125
v_cvt_pk_bf16_f32 v123, v126, v127
s_nop 1
v_mfma_f32_16x16x32_bf16 v[32:35], v[88:91], v[120:123], v[32:35]
v_mfma_f32_16x16x32_bf16 v[36:39], v[92:95], v[120:123], v[36:39]
v_sub_f32 v128, v128, v9
v_sub_f32 v129, v129, v9
v_sub_f32 v130, v130, v9
v_sub_f32 v131, v131, v9
v_sub_f32 v132, v132, v9
v_sub_f32 v133, v133, v9
v_sub_f32 v134, v134, v9
v_sub_f32 v135, v135, v9
v_exp_f32 v128, v128
v_exp_f32 v129, v129
s_add_u32 s9, s20, 12288
buffer_load_dwordx4 v[224:227], v1, s[52:55], s9 offen offset:0 sc1
v_exp_f32 v130, v130
v_exp_f32 v131, v131
s_add_u32 s9, s20, 12288
buffer_load_dwordx4 v[228:231], v1, s[52:55], s9 offen offset:1024 sc1
v_exp_f32 v132, v132
v_exp_f32 v133, v133
s_add_u32 s9, s20, 12288
buffer_load_dwordx4 v[232:235], v1, s[52:55], s9 offen offset:2048 sc1
v_exp_f32 v134, v134
v_exp_f32 v135, v135
s_add_u32 s9, s20, 12288
buffer_load_dwordx4 v[236:239], v1, s[52:55], s9 offen offset:3072 sc1
v_cvt_pk_bf16_f32 v128, v128, v129
v_cvt_pk_bf16_f32 v129, v130, v131
v_cvt_pk_bf16_f32 v130, v132, v133
v_cvt_pk_bf16_f32 v131, v134, v135
s_nop 1
v_mfma_f32_16x16x32_bf16 v[32:35], v[96:99], v[128:131], v[32:35]
v_mfma_f32_16x16x32_bf16 v[36:39], v[100:103], v[128:131], v[36:39]
v_sub_f32 v136, v136, v9
v_sub_f32 v137, v137, v9
v_sub_f32 v138, v138, v9
v_sub_f32 v139, v139, v9
v_sub_f32 v140, v140, v9
v_sub_f32 v141, v141, v9
v_sub_f32 v142, v142, v9
v_sub_f32 v143, v143, v9
v_exp_f32 v136, v136
v_exp_f32 v137, v137
v_exp_f32 v138, v138
v_exp_f32 v139, v139
v_exp_f32 v140, v140
v_exp_f32 v141, v141
v_exp_f32 v142, v142
v_exp_f32 v143, v143
v_cvt_pk_bf16_f32 v136, v136, v137
v_cvt_pk_bf16_f32 v137, v138, v139
v_cvt_pk_bf16_f32 v138, v140, v141
v_cvt_pk_bf16_f32 v139, v142, v143
s_nop 1
v_mfma_f32_16x16x32_bf16 v[32:35], v[40:43], v[136:139], v[32:35]
v_mfma_f32_16x16x32_bf16 v[36:39], v[44:47], v[136:139], v[36:39]
v_sub_f32 v144, v144, v9
v_sub_f32 v145, v145, v9
v_sub_f32 v146, v146, v9
v_sub_f32 v147, v147, v9
v_sub_f32 v148, v148, v9
v_sub_f32 v149, v149, v9
v_sub_f32 v150, v150, v9
v_sub_f32 v151, v151, v9
v_exp_f32 v144, v144
v_exp_f32 v145, v145
v_exp_f32 v146, v146
v_exp_f32 v147, v147
v_exp_f32 v148, v148
v_exp_f32 v149, v149
v_exp_f32 v150, v150
v_exp_f32 v151, v151
v_cvt_pk_bf16_f32 v144, v144, v145
v_cvt_pk_bf16_f32 v145, v146, v147
v_cvt_pk_bf16_f32 v146, v148, v149
v_cvt_pk_bf16_f32 v147, v150, v151
s_waitcnt lgkmcnt(1)
s_nop 0
v_mfma_f32_16x16x32_bf16 v[32:35], v[48:51], v[144:147], v[32:35]
s_waitcnt lgkmcnt(0)
v_mfma_f32_16x16x32_bf16 v[36:39], v[52:55], v[144:147], v[36:39]
s_branch L36
L35:
ds_read_b128 v[176:179], v3 offset:10240
ds_read_b128 v[180:183], v3 offset:11264
ds_read_b128 v[184:187], v3 offset:12288
ds_read_b128 v[188:191], v3 offset:13312
ds_read_b128 v[192:195], v3 offset:14336
ds_read_b128 v[196:199], v3 offset:15360
ds_read_b128 v[200:203], v3 offset:16384
ds_read_b128 v[204:207], v3 offset:17408
s_waitcnt lgkmcnt(7)
v_mfma_f32_16x16x32_bf16 v[144:147], v[176:179], v[28:31], 0
ds_read_b128 v[208:211], v3 offset:34816
s_waitcnt lgkmcnt(7)
v_mfma_f32_16x16x32_bf16 v[148:151], v[180:183], v[28:31], 0
ds_read_b128 v[212:215], v3 offset:35840
s_waitcnt lgkmcnt(7)
v_mfma_f32_16x16x32_bf16 v[152:155], v[184:187], v[28:31], 0
ds_read_b128 v[216:219], v3 offset:36864
s_waitcnt lgkmcnt(7)
v_mfma_f32_16x16x32_bf16 v[156:159], v[188:191], v[28:31], 0
ds_read_b128 v[220:223], v3 offset:37888
s_waitcnt lgkmcnt(7)
v_mfma_f32_16x16x32_bf16 v[160:163], v[192:195], v[28:31], 0
ds_read_b128 v[224:227], v3 offset:38912
s_waitcnt lgkmcnt(7)
v_mfma_f32_16x16x32_bf16 v[164:167], v[196:199], v[28:31], 0
ds_read_b128 v[228:231], v3 offset:39936
s_waitcnt lgkmcnt(7)
v_mfma_f32_16x16x32_bf16 v[168:171], v[200:203], v[28:31], v[248:251]
ds_read_b128 v[232:235], v3 offset:40960
s_waitcnt lgkmcnt(7)
v_mfma_f32_16x16x32_bf16 v[172:175], v[204:207], v[28:31], v[252:255]
ds_read_b128 v[236:239], v3 offset:41984
v_max3_f32 v6, v144, v145, v146
v_max3_f32 v7, v147, v148, v149
v_max3_f32 v6, v6, v150, v151
v_max3_f32 v7, v7, v152, v153
v_max3_f32 v6, v6, v154, v155
v_max3_f32 v7, v7, v156, v157
v_max3_f32 v6, v6, v158, v159
v_max3_f32 v7, v7, v160, v161
v_max3_f32 v6, v6, v162, v163
v_max3_f32 v7, v7, v164, v165
v_max3_f32 v6, v6, v166, v167
v_max3_f32 v7, v7, v168, v169
v_max3_f32 v6, v6, v170, v171
v_max3_f32 v7, v7, v172, v173
v_max3_f32 v6, v6, v174, v175
v_max_f32 v6, v6, v7
v_mov_b32 v7, v6
s_nop 1
v_permlane32_swap_b32 v6, v7
v_max_f32 v6, v6, v7
v_mov_b32 v7, v6
s_nop 1
v_permlane16_swap_b32 v6, v7
v_max_f32 v10, v6, v7
v_sub_f32 v144, v144, v10
v_sub_f32 v145, v145, v10
v_sub_f32 v146, v146, v10
v_sub_f32 v147, v147, v10
v_sub_f32 v148, v148, v10
v_sub_f32 v149, v149, v10
v_sub_f32 v150, v150, v10
v_sub_f32 v151, v151, v10
v_exp_f32 v144, v144
v_exp_f32 v145, v145
v_exp_f32 v146, v146
v_exp_f32 v147, v147
v_exp_f32 v148, v148
v_exp_f32 v149, v149
v_exp_f32 v150, v150
v_exp_f32 v151, v151
v_cvt_pk_bf16_f32 v144, v144, v145
v_cvt_pk_bf16_f32 v145, v146, v147
v_cvt_pk_bf16_f32 v146, v148, v149
v_cvt_pk_bf16_f32 v147, v150, v151
s_waitcnt lgkmcnt(7)
s_nop 0
v_mfma_f32_16x16x32_bf16 v[32:35], v[208:211], v[144:147], 0
s_waitcnt lgkmcnt(6)
v_mfma_f32_16x16x32_bf16 v[36:39], v[212:215], v[144:147], 0
v_sub_f32 v152, v152, v10
v_sub_f32 v153, v153, v10
v_sub_f32 v154, v154, v10
v_sub_f32 v155, v155, v10
v_sub_f32 v156, v156, v10
v_sub_f32 v157, v157, v10
v_sub_f32 v158, v158, v10
v_sub_f32 v159, v159, v10
v_exp_f32 v152, v152
v_exp_f32 v153, v153
v_exp_f32 v154, v154
v_exp_f32 v155, v155
v_exp_f32 v156, v156
v_exp_f32 v157, v157
v_exp_f32 v158, v158
v_exp_f32 v159, v159
v_cvt_pk_bf16_f32 v152, v152, v153
v_cvt_pk_bf16_f32 v153, v154, v155
v_cvt_pk_bf16_f32 v154, v156, v157
v_cvt_pk_bf16_f32 v155, v158, v159
s_waitcnt lgkmcnt(5)
s_nop 0
v_mfma_f32_16x16x32_bf16 v[32:35], v[216:219], v[152:155], v[32:35]
s_waitcnt lgkmcnt(4)
v_mfma_f32_16x16x32_bf16 v[36:39], v[220:223], v[152:155], v[36:39]
v_sub_f32 v160, v160, v10
v_sub_f32 v161, v161, v10
v_sub_f32 v162, v162, v10
v_sub_f32 v163, v163, v10
v_sub_f32 v164, v164, v10
v_sub_f32 v165, v165, v10
v_sub_f32 v166, v166, v10
v_sub_f32 v167, v167, v10
v_exp_f32 v160, v160
v_exp_f32 v161, v161
v_exp_f32 v162, v162
v_exp_f32 v163, v163
v_exp_f32 v164, v164
v_exp_f32 v165, v165
v_exp_f32 v166, v166
v_exp_f32 v167, v167
v_cvt_pk_bf16_f32 v160, v160, v161
v_cvt_pk_bf16_f32 v161, v162, v163
v_cvt_pk_bf16_f32 v162, v164, v165
v_cvt_pk_bf16_f32 v163, v166, v167
s_waitcnt lgkmcnt(3)
s_nop 0
v_mfma_f32_16x16x32_bf16 v[32:35], v[224:227], v[160:163], v[32:35]
s_waitcnt lgkmcnt(2)
v_mfma_f32_16x16x32_bf16 v[36:39], v[228:231], v[160:163], v[36:39]
v_sub_f32 v168, v168, v10
v_sub_f32 v169, v169, v10
v_sub_f32 v170, v170, v10
v_sub_f32 v171, v171, v10
v_sub_f32 v172, v172, v10
v_sub_f32 v173, v173, v10
v_sub_f32 v174, v174, v10
v_sub_f32 v175, v175, v10
v_exp_f32 v168, v168
v_exp_f32 v169, v169
v_exp_f32 v170, v170
v_exp_f32 v171, v171
v_exp_f32 v172, v172
v_exp_f32 v173, v173
v_exp_f32 v174, v174
v_exp_f32 v175, v175
v_cvt_pk_bf16_f32 v168, v168, v169
v_cvt_pk_bf16_f32 v169, v170, v171
v_cvt_pk_bf16_f32 v170, v172, v173
v_cvt_pk_bf16_f32 v171, v174, v175
s_waitcnt lgkmcnt(1)
s_nop 0
v_mfma_f32_16x16x32_bf16 v[32:35], v[232:235], v[168:171], v[32:35]
s_waitcnt lgkmcnt(0)
v_mfma_f32_16x16x32_bf16 v[36:39], v[236:239], v[168:171], v[36:39]
s_cmp_lg_u32 s64, 7
s_cbranch_scc1 L50
v_or_b32 v48, s100, v24
v_mov_b32 v49, v25
v_cmp_eq_u64 vcc, v[26:27], v[48:49]
v_lshlrev_b32 v13, 7, v13
v_mov_b32 v48, 0x80000
v_cndmask_b32 v48, 0, v48, vcc
v_or_b32 v13, v13, v48
L50:
s_lshr_b32 s4, s64, 2
s_and_b32 s5, s64, 3
s_add_u32 s6, s65, s4
s_lshl_b32 s7, s4, 4
s_add_u32 s7, s7, s67
s_sub_u32 s7, s7, 32
s_lshl_b32 s7, s7, 14
s_lshl_b32 s8, s5, 12
s_add_u32 s7, s7, s8
s_add_u32 s7, s7, 0x800000
s_cmp_lt_u32 s6, 2
s_cselect_b32 s7, 0x1700000, s7
s_lshl_b32 s8, s4, 13
s_and_b32 s9, s5, 1
s_lshl_b32 s9, s9, 12
s_add_u32 s8, s8, s9
s_cmp_ge_u32 s5, 2
s_cselect_b32 s9, 24576, 0
s_add_u32 m0, s8, s9
s_barrier
buffer_load_dwordx4 v1, s[52:55], s7 offen offset:0 sc1 lds
buffer_load_dwordx4 v1, s[52:55], s7 offen offset:1024 sc1 lds
buffer_load_dwordx4 v1, s[52:55], s7 offen offset:2048 sc1 lds
buffer_load_dwordx4 v1, s[52:55], s7 offen offset:3072 sc1 lds
s_waitcnt vmcnt(4)
s_cmp_eq_u32 s73, 0
s_cbranch_scc1 L51
s_lshl_b32 s6, s64, 12
s_add_u32 s6, s6, 86016
v_add_u32 v178, s6, v1
ds_write_b128 v178, v[56:59] offset:0
ds_write_b128 v178, v[60:63] offset:1024
ds_write_b128 v178, v[64:67] offset:2048
ds_write_b128 v178, v[68:71] offset:3072
v_lshlrev_b32 v178, 10, v14
v_lshrrev_b32 v179, 2, v15
v_lshl_add_u32 v178, v179, 7, v178
v_and_b32 v179, 3, v0
v_lshl_add_u32 v178, v179, 3, v178
v_add_u32 v178, s6, v178
ds_read_b64_tr_b16 v[72:73], v178 offset:0
ds_read_b64_tr_b16 v[74:75], v178 offset:512
ds_read_b64_tr_b16 v[76:77], v178 offset:32
ds_read_b64_tr_b16 v[78:79], v178 offset:544
ds_read_b64_tr_b16 v[80:81], v178 offset:64
ds_read_b64_tr_b16 v[82:83], v178 offset:576
ds_read_b64_tr_b16 v[84:85], v178 offset:96
ds_read_b64_tr_b16 v[86:87], v178 offset:608
s_waitcnt lgkmcnt(0)
L51:
s_cmp_lg_u32 s64, 7
s_cbranch_scc1 L52
s_mov_b32 s4, 0x20000
buffer_load_dwordx4 v[40:43], v1, s[52:55], s4 offen sc1
buffer_load_dwordx4 v[44:47], v1, s[52:55], s4 offen offset:1024 sc1
s_waitcnt vmcnt(0)
v_cmp_ne_u64 s[12:13], v[40:41], v[24:25]
v_cmp_ne_u64 s[76:77], v[42:43], v[24:25]
v_cmp_ne_u64 s[78:79], v[44:45], v[24:25]
v_cmp_ne_u64 s[80:81], v[46:47], v[24:25]
s_or_b64 s[12:13], s[12:13], s[76:77]
s_or_b64 s[78:79], s[78:79], s[80:81]
s_or_b64 s[12:13], s[12:13], s[78:79]
s_cselect_b32 s68, 0, 1
v_mov_b32 v40, s68
ds_write_b32 v11, v40 offset:0
s_waitcnt lgkmcnt(0)
L52:
s_waitcnt vmcnt(0)
s_barrier
ds_read_b32 v12, v11
ds_read_b128 v[40:43], v3 offset:0
ds_read_b128 v[44:47], v3 offset:1024
ds_read_b128 v[48:51], v3 offset:2048
ds_read_b128 v[52:55], v3 offset:3072
ds_read_b128 v[56:59], v3 offset:4096
ds_read_b128 v[60:63], v3 offset:5120
ds_read_b128 v[88:91], v3 offset:6144
ds_read_b128 v[92:95], v3 offset:7168
ds_read_b128 v[96:99], v3 offset:8192
ds_read_b128 v[100:103], v3 offset:9216
s_mov_b32 s4, s70
buffer_store_dwordx4 v[72:75], v1, s[52:55], s4 offen sc1
s_add_u32 s4, s4, s71
buffer_store_dwordx4 v[76:79], v1, s[52:55], s4 offen sc1
s_add_u32 s4, s4, s71
buffer_store_dwordx4 v[80:83], v1, s[52:55], s4 offen sc1
s_add_u32 s4, s4, s71
buffer_store_dwordx4 v[84:87], v1, s[52:55], s4 offen sc1
s_waitcnt lgkmcnt(10)
v_readfirstlane_b32 s68, v12
s_cmp_lg_u32 s64, 7
s_cselect_b32 s4, s68, 0
s_cmp_lg_u32 s4, 0
s_cselect_b32 s20, s17, 0x1800000
s_waitcnt lgkmcnt(9)
v_mfma_f32_16x16x32_bf16 v[104:107], v[40:43], v[28:31], v[240:243]
ds_read_b128 v[40:43], v3 offset:24576
s_waitcnt lgkmcnt(9)
v_mfma_f32_16x16x32_bf16 v[108:111], v[44:47], v[28:31], v[244:247]
ds_read_b128 v[44:47], v3 offset:25600
s_waitcnt lgkmcnt(9)
v_mfma_f32_16x16x32_bf16 v[112:115], v[48:51], v[28:31], 0
ds_read_b128 v[48:51], v3 offset:26624
s_waitcnt lgkmcnt(9)
v_mfma_f32_16x16x32_bf16 v[116:119], v[52:55], v[28:31], 0
ds_read_b128 v[52:55], v3 offset:27648
s_waitcnt lgkmcnt(9)
v_mfma_f32_16x16x32_bf16 v[120:123], v[56:59], v[28:31], 0
ds_read_b128 v[56:59], v3 offset:28672
s_waitcnt lgkmcnt(9)
v_mfma_f32_16x16x32_bf16 v[124:127], v[60:63], v[28:31], 0
ds_read_b128 v[60:63], v3 offset:29696
s_waitcnt lgkmcnt(9)
v_mfma_f32_16x16x32_bf16 v[128:131], v[88:91], v[28:31], 0
ds_read_b128 v[88:91], v3 offset:30720
s_waitcnt lgkmcnt(9)
v_mfma_f32_16x16x32_bf16 v[132:135], v[92:95], v[28:31], 0
ds_read_b128 v[92:95], v3 offset:31744
s_waitcnt lgkmcnt(9)
v_mfma_f32_16x16x32_bf16 v[136:139], v[96:99], v[28:31], 0
ds_read_b128 v[96:99], v3 offset:32768
s_waitcnt lgkmcnt(9)
v_mfma_f32_16x16x32_bf16 v[140:143], v[100:103], v[28:31], 0
ds_read_b128 v[100:103], v3 offset:33792
s_cmp_ge_u32 s65, 2
s_cbranch_scc1 L53
s_lshl_b32 s4, s65, 3
s_sub_u32 s4, 10, s4
s_cmp_gt_i32 s4, 0
s_cbranch_scc0 L53
v_mov_b32 v104, v5
v_mov_b32 v105, v5
v_mov_b32 v106, v5
v_mov_b32 v107, v5
s_cmp_gt_i32 s4, 1
s_cbranch_scc0 L53
v_mov_b32 v108, v5
v_mov_b32 v109, v5
v_mov_b32 v110, v5
v_mov_b32 v111, v5
s_cmp_gt_i32 s4, 2
s_cbranch_scc0 L53
v_mov_b32 v112, v5
v_mov_b32 v113, v5
v_mov_b32 v114, v5
v_mov_b32 v115, v5
s_cmp_gt_i32 s4, 3
s_cbranch_scc0 L53
v_mov_b32 v116, v5
v_mov_b32 v117, v5
v_mov_b32 v118, v5
v_mov_b32 v119, v5
s_cmp_gt_i32 s4, 4
s_cbranch_scc0 L53
v_mov_b32 v120, v5
v_mov_b32 v121, v5
v_mov_b32 v122, v5
v_mov_b32 v123, v5
s_cmp_gt_i32 s4, 5
s_cbranch_scc0 L53
v_mov_b32 v124, v5
v_mov_b32 v125, v5
v_mov_b32 v126, v5
v_mov_b32 v127, v5
s_cmp_gt_i32 s4, 6
s_cbranch_scc0 L53
v_mov_b32 v128, v5
v_mov_b32 v129, v5
v_mov_b32 v130, v5
v_mov_b32 v131, v5
s_cmp_gt_i32 s4, 7
s_cbranch_scc0 L53
v_mov_b32 v132, v5
v_mov_b32 v133, v5
v_mov_b32 v134, v5
v_mov_b32 v135, v5
s_cmp_gt_i32 s4, 8
s_cbranch_scc0 L53
v_mov_b32 v136, v5
v_mov_b32 v137, v5
v_mov_b32 v138, v5
v_mov_b32 v139, v5
s_cmp_gt_i32 s4, 9
s_cbranch_scc0 L53
v_mov_b32 v140, v5
v_mov_b32 v141, v5
v_mov_b32 v142, v5
v_mov_b32 v143, v5
L53:
v_max3_f32 v6, v104, v105, v106
v_max3_f32 v7, v107, v108, v109
v_max3_f32 v6, v6, v110, v111
v_max3_f32 v7, v7, v112, v113
v_max3_f32 v6, v6, v114, v115
v_max3_f32 v7, v7, v116, v117
v_max3_f32 v6, v6, v118, v119
v_max3_f32 v7, v7, v120, v121
v_max3_f32 v6, v6, v122, v123
v_max3_f32 v7, v7, v124, v125
v_max3_f32 v6, v6, v126, v127
v_max3_f32 v7, v7, v128, v129
v_max3_f32 v6, v6, v130, v131
v_max3_f32 v7, v7, v132, v133
v_max3_f32 v6, v6, v134, v135
v_max3_f32 v7, v7, v136, v137
v_max3_f32 v6, v6, v138, v139
v_max3_f32 v7, v7, v140, v141
v_max3_f32 v6, v6, v142, v143
v_max_f32 v7, v7, v10
v_max_f32 v6, v6, v7
v_mov_b32 v7, v6
s_nop 1
v_permlane32_swap_b32 v6, v7
v_max_f32 v6, v6, v7
v_mov_b32 v7, v6
s_nop 1
v_permlane16_swap_b32 v6, v7
v_max_f32 v9, v6, v7
v_sub_f32 v7, v10, v9
v_exp_f32 v7, v7
s_waitcnt vmcnt(0)
s_waitcnt lgkmcnt(0)
v_mov_b32 v12, 1
s_mov_b64 exec, 1
ds_add_rtn_u32 v12, v11, v12 offset:16
s_waitcnt lgkmcnt(0)
v_readfirstlane_b32 s5, v12
s_nop 0
s_cmp_lg_u32 s5, 7
s_cbranch_scc1 L54
s_lshl_b32 s4, s67, 3
s_add_u32 s4, s4, 0x22000
buffer_store_dwordx2 v[24:25], v1, s[52:55], s4 offen sc1
L54:
s_mov_b64 exec, -1
v_mul_f32 v32, v32, v7
v_mul_f32 v33, v33, v7
v_mul_f32 v34, v34, v7
v_mul_f32 v35, v35, v7
v_mul_f32 v36, v36, v7
v_mul_f32 v37, v37, v7
v_mul_f32 v38, v38, v7
v_mul_f32 v39, v39, v7
v_sub_f32 v104, v104, v9
v_sub_f32 v105, v105, v9
v_sub_f32 v106, v106, v9
v_sub_f32 v107, v107, v9
v_sub_f32 v108, v108, v9
v_sub_f32 v109, v109, v9
v_sub_f32 v110, v110, v9
v_sub_f32 v111, v111, v9
v_exp_f32 v104, v104
v_exp_f32 v105, v105
buffer_load_dwordx4 v[176:179], v1, s[52:55], s20 offen offset:0 sc1
v_exp_f32 v106, v106
v_exp_f32 v107, v107
buffer_load_dwordx4 v[180:183], v1, s[52:55], s20 offen offset:1024 sc1
v_exp_f32 v108, v108
v_exp_f32 v109, v109
buffer_load_dwordx4 v[184:187], v1, s[52:55], s20 offen offset:2048 sc1
v_exp_f32 v110, v110
v_exp_f32 v111, v111
buffer_load_dwordx4 v[188:191], v1, s[52:55], s20 offen offset:3072 sc1
v_cvt_pk_bf16_f32 v104, v104, v105
v_cvt_pk_bf16_f32 v105, v106, v107
v_cvt_pk_bf16_f32 v106, v108, v109
v_cvt_pk_bf16_f32 v107, v110, v111
s_nop 1
v_mfma_f32_16x16x32_bf16 v[32:35], v[40:43], v[104:107], v[32:35]
v_mfma_f32_16x16x32_bf16 v[36:39], v[44:47], v[104:107], v[36:39]
v_sub_f32 v112, v112, v9
v_sub_f32 v113, v113, v9
v_sub_f32 v114, v114, v9
v_sub_f32 v115, v115, v9
v_sub_f32 v116, v116, v9
v_sub_f32 v117, v117, v9
v_sub_f32 v118, v118, v9
v_sub_f32 v119, v119, v9
v_exp_f32 v112, v112
v_exp_f32 v113, v113
s_add_u32 s9, s20, 4096
buffer_load_dwordx4 v[192:195], v1, s[52:55], s9 offen offset:0 sc1
v_exp_f32 v114, v114
v_exp_f32 v115, v115
s_add_u32 s9, s20, 4096
buffer_load_dwordx4 v[196:199], v1, s[52:55], s9 offen offset:1024 sc1
v_exp_f32 v116, v116
v_exp_f32 v117, v117
s_add_u32 s9, s20, 4096
buffer_load_dwordx4 v[200:203], v1, s[52:55], s9 offen offset:2048 sc1
v_exp_f32 v118, v118
v_exp_f32 v119, v119
s_add_u32 s9, s20, 4096
buffer_load_dwordx4 v[204:207], v1, s[52:55], s9 offen offset:3072 sc1
v_cvt_pk_bf16_f32 v112, v112, v113
v_cvt_pk_bf16_f32 v113, v114, v115
v_cvt_pk_bf16_f32 v114, v116, v117
v_cvt_pk_bf16_f32 v115, v118, v119
s_nop 1
v_mfma_f32_16x16x32_bf16 v[32:35], v[48:51], v[112:115], v[32:35]
v_mfma_f32_16x16x32_bf16 v[36:39], v[52:55], v[112:115], v[36:39]
v_sub_f32 v120, v120, v9
v_sub_f32 v121, v121, v9
v_sub_f32 v122, v122, v9
v_sub_f32 v123, v123, v9
v_sub_f32 v124, v124, v9
v_sub_f32 v125, v125, v9
v_sub_f32 v126, v126, v9
v_sub_f32 v127, v127, v9
v_exp_f32 v120, v120
v_exp_f32 v121, v121
s_add_u32 s9, s20, 8192
buffer_load_dwordx4 v[208:211], v1, s[52:55], s9 offen offset:0 sc1
v_exp_f32 v122, v122
v_exp_f32 v123, v123
s_add_u32 s9, s20, 8192
buffer_load_dwordx4 v[212:215], v1, s[52:55], s9 offen offset:1024 sc1
v_exp_f32 v124, v124
v_exp_f32 v125, v125
s_add_u32 s9, s20, 8192
buffer_load_dwordx4 v[216:219], v1, s[52:55], s9 offen offset:2048 sc1
v_exp_f32 v126, v126
v_exp_f32 v127, v127
s_add_u32 s9, s20, 8192
buffer_load_dwordx4 v[220:223], v1, s[52:55], s9 offen offset:3072 sc1
v_cvt_pk_bf16_f32 v120, v120, v121
v_cvt_pk_bf16_f32 v121, v122, v123
v_cvt_pk_bf16_f32 v122, v124, v125
v_cvt_pk_bf16_f32 v123, v126, v127
s_nop 1
v_mfma_f32_16x16x32_bf16 v[32:35], v[56:59], v[120:123], v[32:35]
v_mfma_f32_16x16x32_bf16 v[36:39], v[60:63], v[120:123], v[36:39]
v_sub_f32 v128, v128, v9
v_sub_f32 v129, v129, v9
v_sub_f32 v130, v130, v9
v_sub_f32 v131, v131, v9
v_sub_f32 v132, v132, v9
v_sub_f32 v133, v133, v9
v_sub_f32 v134, v134, v9
v_sub_f32 v135, v135, v9
v_exp_f32 v128, v128
v_exp_f32 v129, v129
s_add_u32 s9, s20, 12288
buffer_load_dwordx4 v[224:227], v1, s[52:55], s9 offen offset:0 sc1
v_exp_f32 v130, v130
v_exp_f32 v131, v131
s_add_u32 s9, s20, 12288
buffer_load_dwordx4 v[228:231], v1, s[52:55], s9 offen offset:1024 sc1
v_exp_f32 v132, v132
v_exp_f32 v133, v133
s_add_u32 s9, s20, 12288
buffer_load_dwordx4 v[232:235], v1, s[52:55], s9 offen offset:2048 sc1
v_exp_f32 v134, v134
v_exp_f32 v135, v135
s_add_u32 s9, s20, 12288
buffer_load_dwordx4 v[236:239], v1, s[52:55], s9 offen offset:3072 sc1
v_cvt_pk_bf16_f32 v128, v128, v129
v_cvt_pk_bf16_f32 v129, v130, v131
v_cvt_pk_bf16_f32 v130, v132, v133
v_cvt_pk_bf16_f32 v131, v134, v135
s_nop 1
v_mfma_f32_16x16x32_bf16 v[32:35], v[88:91], v[128:131], v[32:35]
v_mfma_f32_16x16x32_bf16 v[36:39], v[92:95], v[128:131], v[36:39]
v_sub_f32 v136, v136, v9
v_sub_f32 v137, v137, v9
v_sub_f32 v138, v138, v9
v_sub_f32 v139, v139, v9
v_sub_f32 v140, v140, v9
v_sub_f32 v141, v141, v9
v_sub_f32 v142, v142, v9
v_sub_f32 v143, v143, v9
v_exp_f32 v136, v136
v_exp_f32 v137, v137
v_exp_f32 v138, v138
v_exp_f32 v139, v139
v_exp_f32 v140, v140
v_exp_f32 v141, v141
v_exp_f32 v142, v142
v_exp_f32 v143, v143
v_cvt_pk_bf16_f32 v136, v136, v137
v_cvt_pk_bf16_f32 v137, v138, v139
v_cvt_pk_bf16_f32 v138, v140, v141
v_cvt_pk_bf16_f32 v139, v142, v143
s_nop 1
v_mfma_f32_16x16x32_bf16 v[32:35], v[96:99], v[136:139], v[32:35]
v_mfma_f32_16x16x32_bf16 v[36:39], v[100:103], v[136:139], v[36:39]
L36:
s_lshl_b32 s4, s65, 3
s_add_u32 s4, s4, s64
s_lshl_b32 s4, s4, 4
s_add_u32 s4, s4, s66
s_lshl_b32 s4, s4, 10
s_add_u32 s4, s4, 0xc00000
s_nop 1
v_mov_b32 v6, v36
v_mov_b32 v7, v6
s_nop 1
v_permlane32_swap_b32 v6, v7
v_mov_b32 v6, v7
s_nop 1
v_permlane16_swap_b32 v7, v6
v_rcp_f32 v6, v6
s_nop 0
v_mul_f32 v32, v32, v6
v_mul_f32 v33, v33, v6
v_mul_f32 v34, v34, v6
v_mul_f32 v35, v35, v6
v_mul_f32 v36, v36, v6
v_mul_f32 v37, v37, v6
v_mul_f32 v38, v38, v6
v_mul_f32 v39, v39, v6
v_cvt_pk_bf16_f32 v40, v32, v33
v_cvt_pk_bf16_f32 v41, v34, v35
v_cvt_pk_bf16_f32 v42, v36, v37
v_cvt_pk_bf16_f32 v43, v38, v39
buffer_store_dwordx4 v[40:43], v1, s[52:55], s4 offen sc1
s_cmp_lg_u32 s64, 7
s_cbranch_scc1 L55
s_cmp_lg_u32 s68, 0
s_cbranch_scc1 L57
s_mov_b32 s10, 0
L56:
s_add_u32 s10, s10, 1
s_cmp_gt_u32 s10, 0x40000
s_cbranch_scc1 L57
s_mov_b32 s4, 0x20000
buffer_load_dwordx4 v[44:47], v1, s[52:55], s4 offen sc1
buffer_load_dwordx4 v[48:51], v1, s[52:55], s4 offen offset:1024 sc1
s_waitcnt vmcnt(0)
v_cmp_ne_u64 s[12:13], v[44:45], v[24:25]
v_cmp_ne_u64 s[76:77], v[46:47], v[24:25]
v_cmp_ne_u64 s[78:79], v[48:49], v[24:25]
v_cmp_ne_u64 s[80:81], v[50:51], v[24:25]
s_or_b64 s[12:13], s[12:13], s[76:77]
s_or_b64 s[78:79], s[78:79], s[80:81]
s_or_b64 s[12:13], s[12:13], s[78:79]
s_cbranch_scc1 L56
L57:
s_mov_b32 s4, 0x22000
buffer_load_dwordx4 v[44:47], v1, s[52:55], s4 offen sc1
buffer_load_dwordx4 v[48:51], v1, s[52:55], s4 offen offset:1024 sc1
s_waitcnt vmcnt(0)
v_cmp_ne_u64 s[12:13], v[44:45], v[24:25]
v_cmp_ne_u64 s[76:77], v[46:47], v[24:25]
v_cmp_ne_u64 s[78:79], v[48:49], v[24:25]
v_cmp_ne_u64 s[80:81], v[50:51], v[24:25]
s_or_b64 s[12:13], s[12:13], s[76:77]
s_or_b64 s[78:79], s[78:79], s[80:81]
s_or_b64 s[12:13], s[12:13], s[78:79]
s_cselect_b32 s68, 0, 1
v_mov_b32 v44, s68
ds_write_b32 v11, v44 offset:20
s_waitcnt lgkmcnt(0)
L55:
s_waitcnt vmcnt(0)
s_barrier
s_lshl_b32 s4, s67, 7
s_cmp_lg_u32 s64, 5
s_cbranch_scc1 L58
s_add_u32 s4, s4, 0x88000
s_mov_b64 exec, 1
buffer_store_dwordx2 v[24:25], v1, s[52:55], s4 offen
s_mov_b64 exec, -1
L58:
s_cmp_lg_u32 s64, 6
s_cbranch_scc1 L59
s_add_u32 s4, s4, 0x8000
s_mov_b64 exec, 1
buffer_store_dwordx2 v[24:25], v1, s[52:55], s4 offen sc1
s_mov_b64 exec, -1
L59:
s_cmp_eq_u32 s64, 7
s_cbranch_scc1 L_w7path
s_cmp_lg_u32 s68, 0
s_cbranch_scc1 L60
buffer_load_dwordx4 v[176:179], v1, s[52:55], s17 offen offset:0 sc1
buffer_load_dwordx4 v[180:183], v1, s[52:55], s17 offen offset:1024 sc1
buffer_load_dwordx4 v[184:187], v1, s[52:55], s17 offen offset:2048 sc1
buffer_load_dwordx4 v[188:191], v1, s[52:55], s17 offen offset:3072 sc1
s_add_u32 s9, s17, 4096
buffer_load_dwordx4 v[192:195], v1, s[52:55], s9 offen offset:0 sc1
s_add_u32 s9, s17, 4096
buffer_load_dwordx4 v[196:199], v1, s[52:55], s9 offen offset:1024 sc1
s_add_u32 s9, s17, 4096
buffer_load_dwordx4 v[200:203], v1, s[52:55], s9 offen offset:2048 sc1
s_add_u32 s9, s17, 4096
buffer_load_dwordx4 v[204:207], v1, s[52:55], s9 offen offset:3072 sc1
s_add_u32 s9, s17, 8192
buffer_load_dwordx4 v[208:211], v1, s[52:55], s9 offen offset:0 sc1
s_add_u32 s9, s17, 8192
buffer_load_dwordx4 v[212:215], v1, s[52:55], s9 offen offset:1024 sc1
s_add_u32 s9, s17, 8192
buffer_load_dwordx4 v[216:219], v1, s[52:55], s9 offen offset:2048 sc1
s_add_u32 s9, s17, 8192
buffer_load_dwordx4 v[220:223], v1, s[52:55], s9 offen offset:3072 sc1
s_add_u32 s9, s17, 12288
buffer_load_dwordx4 v[224:227], v1, s[52:55], s9 offen offset:0 sc1
s_add_u32 s9, s17, 12288
buffer_load_dwordx4 v[228:231], v1, s[52:55], s9 offen offset:1024 sc1
s_add_u32 s9, s17, 12288
buffer_load_dwordx4 v[232:235], v1, s[52:55], s9 offen offset:2048 sc1
s_add_u32 s9, s17, 12288
buffer_load_dwordx4 v[236:239], v1, s[52:55], s9 offen offset:3072 sc1
L60:
ds_read_b32 v12, v11 offset:20
s_waitcnt lgkmcnt(0)
v_readfirstlane_b32 s68, v12
s_nop 0
s_cmp_eq_u32 s68, 0
s_cbranch_scc1 L61
buffer_load_dwordx4 v[64:67], v1, s[52:55], s18 offen offset:0 sc1
buffer_load_dwordx4 v[68:71], v1, s[52:55], s18 offen offset:1024 sc1
buffer_load_dwordx4 v[72:75], v1, s[52:55], s18 offen offset:2048 sc1
buffer_load_dwordx4 v[76:79], v1, s[52:55], s18 offen offset:3072 sc1
s_add_u32 s9, s18, 4096
buffer_load_dwordx4 v[80:83], v1, s[52:55], s9 offen offset:0 sc1
s_add_u32 s9, s18, 4096
buffer_load_dwordx4 v[84:87], v1, s[52:55], s9 offen offset:1024 sc1
s_add_u32 s9, s18, 4096
buffer_load_dwordx4 v[88:91], v1, s[52:55], s9 offen offset:2048 sc1
s_add_u32 s9, s18, 4096
buffer_load_dwordx4 v[92:95], v1, s[52:55], s9 offen offset:3072 sc1
L61:
v_and_b32 v5, 1, v14
v_lshrrev_b32 v6, 1, v14
v_lshlrev_b32 v7, 4, v15
v_lshl_add_u32 v7, v6, 8, v7
v_mul_u32_u24 v8, 57344, v5
v_add_u32 v8, v8, v7
v_lshl_add_u32 v10, v5, 6, v15
v_mul_u32_u24 v10, 896, v10
v_lshl_add_u32 v10, v6, 4, v10
v_add_u32 v3, 114688, v1
v_lshlrev_b32 v9, 4, v15
v_add_u32 v9, 157696, v9
s_lshr_b32 s6, s64, 2
s_lshl_b32 s6, s6, 2
s_add_u32 s4, s23, s6
s_lshl_b32 s4, s4, 14
s_and_b32 s6, s64, 3
s_lshl_b32 s6, s6, 12
s_add_u32 s7, s4, s6
s_add_u32 s7, s7, 0xc00000
s_lshl_b32 s5, s64, 12
s_add_u32 m0, s5, 114688
s_barrier
buffer_load_dwordx4 v1, s[52:55], s7 offen offset:0 sc1 lds
buffer_load_dwordx4 v1, s[52:55], s7 offen offset:1024 sc1 lds
buffer_load_dwordx4 v1, s[52:55], s7 offen offset:2048 sc1 lds
buffer_load_dwordx4 v1, s[52:55], s7 offen offset:3072 sc1 lds
s_waitcnt vmcnt(0)
s_barrier
ds_read_b32 v12, v11 offset:20
ds_read_b128 v[32:35], v3 offset:0
ds_read_b128 v[36:39], v3 offset:16384
ds_read_b128 v[40:43], v3 offset:1024
ds_read_b128 v[44:47], v3 offset:17408
ds_read_b128 v[48:51], v3 offset:2048
ds_read_b128 v[52:55], v3 offset:18432
ds_read_b128 v[56:59], v3 offset:3072
ds_read_b128 v[60:63], v3 offset:19456
s_waitcnt lgkmcnt(8)
v_readfirstlane_b32 s69, v12
s_nop 0
s_cmp_lg_u32 s69, 0
s_cselect_b32 s20, s18, 0x1800000
s_waitcnt lgkmcnt(7)
v_mfma_f32_16x16x32_bf16 v[240:243], v[176:179], v[32:35], 0
s_waitcnt lgkmcnt(6)
v_mfma_f32_16x16x32_bf16 v[244:247], v[176:179], v[36:39], 0
ds_read_b128 v[32:35], v3 offset:4096
ds_read_b128 v[36:39], v3 offset:20480
s_add_u32 s9, s20, 8192
buffer_load_dwordx4 v[96:99], v1, s[52:55], s9 offen offset:0 sc1
s_waitcnt lgkmcnt(7)
v_mfma_f32_16x16x32_bf16 v[240:243], v[180:183], v[40:43], v[240:243]
s_waitcnt lgkmcnt(6)
v_mfma_f32_16x16x32_bf16 v[244:247], v[180:183], v[44:47], v[244:247]
ds_read_b128 v[40:43], v3 offset:5120
ds_read_b128 v[44:47], v3 offset:21504
s_add_u32 s9, s20, 8192
buffer_load_dwordx4 v[100:103], v1, s[52:55], s9 offen offset:1024 sc1
s_waitcnt lgkmcnt(7)
v_mfma_f32_16x16x32_bf16 v[240:243], v[184:187], v[48:51], v[240:243]
s_waitcnt lgkmcnt(6)
v_mfma_f32_16x16x32_bf16 v[244:247], v[184:187], v[52:55], v[244:247]
ds_read_b128 v[48:51], v3 offset:6144
ds_read_b128 v[52:55], v3 offset:22528
s_add_u32 s9, s20, 8192
buffer_load_dwordx4 v[104:107], v1, s[52:55], s9 offen offset:2048 sc1
s_waitcnt lgkmcnt(7)
v_mfma_f32_16x16x32_bf16 v[240:243], v[188:191], v[56:59], v[240:243]
s_waitcnt lgkmcnt(6)
v_mfma_f32_16x16x32_bf16 v[244:247], v[188:191], v[60:63], v[244:247]
ds_read_b128 v[56:59], v3 offset:7168
ds_read_b128 v[60:63], v3 offset:23552
s_add_u32 s9, s20, 8192
buffer_load_dwordx4 v[108:111], v1, s[52:55], s9 offen offset:3072 sc1
s_waitcnt lgkmcnt(7)
v_mfma_f32_16x16x32_bf16 v[240:243], v[192:195], v[32:35], v[240:243]
s_waitcnt lgkmcnt(6)
v_mfma_f32_16x16x32_bf16 v[244:247], v[192:195], v[36:39], v[244:247]
ds_read_b128 v[32:35], v3 offset:8192
ds_read_b128 v[36:39], v3 offset:24576
s_add_u32 s9, s20, 12288
buffer_load_dwordx4 v[112:115], v1, s[52:55], s9 offen offset:0 sc1
s_waitcnt lgkmcnt(7)
v_mfma_f32_16x16x32_bf16 v[240:243], v[196:199], v[40:43], v[240:243]
s_waitcnt lgkmcnt(6)
v_mfma_f32_16x16x32_bf16 v[244:247], v[196:199], v[44:47], v[244:247]
ds_read_b128 v[40:43], v3 offset:9216
ds_read_b128 v[44:47], v3 offset:25600
s_add_u32 s9, s20, 12288
buffer_load_dwordx4 v[116:119], v1, s[52:55], s9 offen offset:1024 sc1
s_waitcnt lgkmcnt(7)
v_mfma_f32_16x16x32_bf16 v[240:243], v[200:203], v[48:51], v[240:243]
s_waitcnt lgkmcnt(6)
v_mfma_f32_16x16x32_bf16 v[244:247], v[200:203], v[52:55], v[244:247]
ds_read_b128 v[48:51], v3 offset:10240
ds_read_b128 v[52:55], v3 offset:26624
s_waitcnt lgkmcnt(7)
v_mfma_f32_16x16x32_bf16 v[240:243], v[204:207], v[56:59], v[240:243]
s_waitcnt lgkmcnt(6)
v_mfma_f32_16x16x32_bf16 v[244:247], v[204:207], v[60:63], v[244:247]
ds_read_b128 v[56:59], v3 offset:11264
ds_read_b128 v[60:63], v3 offset:27648
s_waitcnt lgkmcnt(7)
v_mfma_f32_16x16x32_bf16 v[240:243], v[208:211], v[32:35], v[240:243]
s_waitcnt lgkmcnt(6)
v_mfma_f32_16x16x32_bf16 v[244:247], v[208:211], v[36:39], v[244:247]
ds_read_b128 v[32:35], v3 offset:12288
ds_read_b128 v[36:39], v3 offset:28672
s_waitcnt lgkmcnt(7)
v_mfma_f32_16x16x32_bf16 v[240:243], v[212:215], v[40:43], v[240:243]
s_waitcnt lgkmcnt(6)
v_mfma_f32_16x16x32_bf16 v[244:247], v[212:215], v[44:47], v[244:247]
ds_read_b128 v[40:43], v3 offset:13312
ds_read_b128 v[44:47], v3 offset:29696
s_waitcnt lgkmcnt(7)
v_mfma_f32_16x16x32_bf16 v[240:243], v[216:219], v[48:51], v[240:243]
s_waitcnt lgkmcnt(6)
v_mfma_f32_16x16x32_bf16 v[244:247], v[216:219], v[52:55], v[244:247]
ds_read_b128 v[48:51], v3 offset:14336
ds_read_b128 v[52:55], v3 offset:30720
s_waitcnt lgkmcnt(7)
v_mfma_f32_16x16x32_bf16 v[240:243], v[220:223], v[56:59], v[240:243]
s_waitcnt lgkmcnt(6)
v_mfma_f32_16x16x32_bf16 v[244:247], v[220:223], v[60:63], v[244:247]
ds_read_b128 v[56:59], v3 offset:15360
ds_read_b128 v[60:63], v3 offset:31744
s_waitcnt lgkmcnt(7)
v_mfma_f32_16x16x32_bf16 v[240:243], v[224:227], v[32:35], v[240:243]
s_waitcnt lgkmcnt(6)
v_mfma_f32_16x16x32_bf16 v[244:247], v[224:227], v[36:39], v[244:247]
s_waitcnt lgkmcnt(5)
v_mfma_f32_16x16x32_bf16 v[240:243], v[228:231], v[40:43], v[240:243]
s_waitcnt lgkmcnt(4)
v_mfma_f32_16x16x32_bf16 v[244:247], v[228:231], v[44:47], v[244:247]
s_waitcnt lgkmcnt(3)
v_mfma_f32_16x16x32_bf16 v[240:243], v[232:235], v[48:51], v[240:243]
s_waitcnt lgkmcnt(2)
v_mfma_f32_16x16x32_bf16 v[244:247], v[232:235], v[52:55], v[244:247]
s_waitcnt lgkmcnt(1)
v_mfma_f32_16x16x32_bf16 v[240:243], v[236:239], v[56:59], v[240:243]
s_waitcnt lgkmcnt(0)
v_mfma_f32_16x16x32_bf16 v[244:247], v[236:239], v[60:63], v[244:247]
v_lshlrev_b32 v32, 16, v20
v_and_b32 v33, 0xffff0000, v20
v_lshlrev_b32 v34, 16, v21
v_and_b32 v35, 0xffff0000, v21
v_lshlrev_b32 v36, 16, v22
v_and_b32 v37, 0xffff0000, v22
v_lshlrev_b32 v38, 16, v23
v_and_b32 v39, 0xffff0000, v23
s_mul_i32 s4, s23, 14336
s_lshl_b32 s5, s22, 9
s_add_u32 s4, s4, s5
s_add_u32 s4, s4, 0xe00000
v_add_f32 v32, v32, v240
v_add_f32 v33, v33, v241
v_add_f32 v34, v34, v242
v_add_f32 v35, v35, v243
v_add_f32 v36, v36, v244
v_add_f32 v37, v37, v245
v_add_f32 v38, v38, v246
v_add_f32 v39, v39, v247
v_cvt_pk_bf16_f32 v40, v32, v33
v_cvt_pk_bf16_f32 v41, v34, v35
v_cvt_pk_bf16_f32 v42, v36, v37
v_cvt_pk_bf16_f32 v43, v38, v39
v_mov_b32 v20, v40
v_mov_b32 v21, v41
v_mov_b32 v22, v42
v_mov_b32 v23, v43
v_permlane16_swap_b32 v40, v42
v_permlane16_swap_b32 v41, v43
buffer_store_dwordx4 v[40:43], v8, s[52:55], s4 offen sc1
s_waitcnt vmcnt(0)
s_barrier
s_lshl_b32 s4, s67, 7
s_cmp_lg_u32 s64, 5
s_cbranch_scc1 L62
s_add_u32 s4, s4, 0x90000
s_mov_b64 exec, 1
buffer_store_dwordx2 v[24:25], v1, s[52:55], s4 offen
s_mov_b64 exec, -1
L62:
s_cmp_lg_u32 s64, 6
s_cbranch_scc1 L63
s_add_u32 s4, s4, 0x10000
s_mov_b64 exec, 1
buffer_store_dwordx2 v[24:25], v1, s[52:55], s4 offen sc1
s_mov_b64 exec, -1
L63:
s_cmp_lg_u32 s68, 0
s_cbranch_scc1 L64
buffer_load_dwordx4 v[64:67], v1, s[52:55], s18 offen offset:0 sc1
buffer_load_dwordx4 v[68:71], v1, s[52:55], s18 offen offset:1024 sc1
buffer_load_dwordx4 v[72:75], v1, s[52:55], s18 offen offset:2048 sc1
buffer_load_dwordx4 v[76:79], v1, s[52:55], s18 offen offset:3072 sc1
s_add_u32 s9, s18, 4096
buffer_load_dwordx4 v[80:83], v1, s[52:55], s9 offen offset:0 sc1
s_add_u32 s9, s18, 4096
buffer_load_dwordx4 v[84:87], v1, s[52:55], s9 offen offset:1024 sc1
s_add_u32 s9, s18, 4096
buffer_load_dwordx4 v[88:91], v1, s[52:55], s9 offen offset:2048 sc1
s_add_u32 s9, s18, 4096
buffer_load_dwordx4 v[92:95], v1, s[52:55], s9 offen offset:3072 sc1
L64:
s_cmp_lg_u32 s69, 0
s_cbranch_scc1 L65
s_add_u32 s9, s18, 8192
buffer_load_dwordx4 v[96:99], v1, s[52:55], s9 offen offset:0 sc1
s_add_u32 s9, s18, 8192
buffer_load_dwordx4 v[100:103], v1, s[52:55], s9 offen offset:1024 sc1
s_add_u32 s9, s18, 8192
buffer_load_dwordx4 v[104:107], v1, s[52:55], s9 offen offset:2048 sc1
s_add_u32 s9, s18, 8192
buffer_load_dwordx4 v[108:111], v1, s[52:55], s9 offen offset:3072 sc1
s_add_u32 s9, s18, 12288
buffer_load_dwordx4 v[112:115], v1, s[52:55], s9 offen offset:0 sc1
s_add_u32 s9, s18, 12288
buffer_load_dwordx4 v[116:119], v1, s[52:55], s9 offen offset:1024 sc1
L65:
s_add_u32 s9, s18, 12288
buffer_load_dwordx4 v[120:123], v1, s[52:55], s9 offen offset:2048 sc1
s_add_u32 s9, s18, 12288
buffer_load_dwordx4 v[124:127], v1, s[52:55], s9 offen offset:3072 sc1
s_add_u32 s9, s18, 16384
buffer_load_dwordx4 v[128:131], v1, s[52:55], s9 offen offset:0 sc1
s_add_u32 s9, s18, 16384
buffer_load_dwordx4 v[132:135], v1, s[52:55], s9 offen offset:1024 sc1
s_add_u32 s9, s18, 16384
buffer_load_dwordx4 v[136:139], v1, s[52:55], s9 offen offset:2048 sc1
s_add_u32 s9, s18, 16384
buffer_load_dwordx4 v[140:143], v1, s[52:55], s9 offen offset:3072 sc1
s_waitcnt vmcnt(5)
v_mfma_f32_16x16x32_bf16 v[240:243], v[64:67], v[16:19], 0
v_mfma_f32_16x16x32_bf16 v[244:247], v[68:71], v[16:19], 0
v_mfma_f32_16x16x32_bf16 v[240:243], v[72:75], v[16:19], v[240:243]
v_mfma_f32_16x16x32_bf16 v[244:247], v[76:79], v[16:19], v[244:247]
v_mfma_f32_16x16x32_bf16 v[240:243], v[80:83], v[16:19], v[240:243]
v_mfma_f32_16x16x32_bf16 v[244:247], v[84:87], v[16:19], v[244:247]
v_mfma_f32_16x16x32_bf16 v[240:243], v[88:91], v[16:19], v[240:243]
v_mfma_f32_16x16x32_bf16 v[244:247], v[92:95], v[16:19], v[244:247]
v_mfma_f32_16x16x32_bf16 v[240:243], v[96:99], v[16:19], v[240:243]
v_mfma_f32_16x16x32_bf16 v[244:247], v[100:103], v[16:19], v[244:247]
v_mfma_f32_16x16x32_bf16 v[240:243], v[104:107], v[16:19], v[240:243]
v_mfma_f32_16x16x32_bf16 v[244:247], v[108:111], v[16:19], v[244:247]
v_mfma_f32_16x16x32_bf16 v[240:243], v[112:115], v[16:19], v[240:243]
v_mfma_f32_16x16x32_bf16 v[244:247], v[116:119], v[16:19], v[244:247]
s_and_b32 s6, s64, 3
s_mul_i32 s27, s6, 14336
s_lshr_b32 s8, s64, 2
s_lshl_b32 s6, s8, 10
s_add_u32 s27, s27, s6
s_mul_i32 s26, s101, 114688
s_add_u32 s26, s26, s27
s_add_u32 s26, s26, 0xe00000
s_barrier
s_add_u32 m0, s27, 0
s_add_u32 s6, s26, 0
buffer_load_dwordx4 v1, s[52:55], s6 offen sc1 lds
s_add_u32 m0, s27, 2048
s_add_u32 s6, s26, 2048
buffer_load_dwordx4 v1, s[52:55], s6 offen sc1 lds
s_add_u32 m0, s27, 4096
s_add_u32 s6, s26, 4096
buffer_load_dwordx4 v1, s[52:55], s6 offen sc1 lds
s_add_u32 m0, s27, 6144
s_add_u32 s6, s26, 6144
buffer_load_dwordx4 v1, s[52:55], s6 offen sc1 lds
s_add_u32 m0, s27, 8192
s_add_u32 s6, s26, 8192
buffer_load_dwordx4 v1, s[52:55], s6 offen sc1 lds
s_add_u32 m0, s27, 10240
s_add_u32 s6, s26, 10240
buffer_load_dwordx4 v1, s[52:55], s6 offen sc1 lds
s_add_u32 m0, s27, 12288
s_add_u32 s6, s26, 12288
buffer_load_dwordx4 v1, s[52:55], s6 offen sc1 lds
v_mfma_f32_16x16x32_bf16 v[240:243], v[120:123], v[16:19], v[240:243]
s_waitcnt vmcnt(11)
v_mfma_f32_16x16x32_bf16 v[244:247], v[124:127], v[16:19], v[244:247]
s_waitcnt vmcnt(10)
v_mfma_f32_16x16x32_bf16 v[240:243], v[128:131], v[16:19], v[240:243]
s_waitcnt vmcnt(9)
v_mfma_f32_16x16x32_bf16 v[244:247], v[132:135], v[16:19], v[244:247]
s_waitcnt vmcnt(8)
v_mfma_f32_16x16x32_bf16 v[240:243], v[136:139], v[16:19], v[240:243]
s_waitcnt vmcnt(7)
v_mfma_f32_16x16x32_bf16 v[244:247], v[140:143], v[16:19], v[244:247]
s_mul_i32 s20, s101, 458752
s_lshl_b32 s5, s16, 9
s_add_u32 s20, s20, s5
s_add_u32 s20, s20, 0x1000000
s_mul_i32 s21, s64, 6144
s_add_u32 s21, s21, 114688
s_waitcnt vmcnt(6)
s_barrier
ds_read_b128 v[32:35], v1 offset:0
ds_read_b128 v[36:39], v1 offset:14336
ds_read_b128 v[40:43], v1 offset:28672
ds_read_b128 v[44:47], v1 offset:43008
ds_read_b128 v[48:51], v1 offset:1024
ds_read_b128 v[52:55], v1 offset:15360
ds_read_b128 v[56:59], v1 offset:29696
ds_read_b128 v[60:63], v1 offset:44032
s_waitcnt vmcnt(4)
s_barrier
s_waitcnt lgkmcnt(7)
v_mfma_f32_16x16x32_bf16 v[176:179], v[64:67], v[32:35], 0
v_mfma_f32_16x16x32_bf16 v[180:183], v[68:71], v[32:35], 0
ds_read_b128 v[32:35], v1 offset:2048
s_waitcnt lgkmcnt(7)
v_mfma_f32_16x16x32_bf16 v[184:187], v[64:67], v[36:39], 0
v_mfma_f32_16x16x32_bf16 v[188:191], v[68:71], v[36:39], 0
ds_read_b128 v[36:39], v1 offset:16384
s_waitcnt lgkmcnt(7)
v_mfma_f32_16x16x32_bf16 v[192:195], v[64:67], v[40:43], 0
v_mfma_f32_16x16x32_bf16 v[196:199], v[68:71], v[40:43], 0
ds_read_b128 v[40:43], v1 offset:30720
s_waitcnt lgkmcnt(7)
v_mfma_f32_16x16x32_bf16 v[200:203], v[64:67], v[44:47], 0
v_mfma_f32_16x16x32_bf16 v[204:207], v[68:71], v[44:47], 0
ds_read_b128 v[44:47], v1 offset:45056
s_add_u32 m0, s27, 57344
s_add_u32 s6, s26, 57344
buffer_load_dwordx4 v1, s[52:55], s6 offen sc1 lds
s_waitcnt lgkmcnt(7)
v_mfma_f32_16x16x32_bf16 v[176:179], v[72:75], v[48:51], v[176:179]
v_mfma_f32_16x16x32_bf16 v[180:183], v[76:79], v[48:51], v[180:183]
ds_read_b128 v[48:51], v1 offset:3072
s_waitcnt lgkmcnt(7)
v_mfma_f32_16x16x32_bf16 v[184:187], v[72:75], v[52:55], v[184:187]
v_mfma_f32_16x16x32_bf16 v[188:191], v[76:79], v[52:55], v[188:191]
ds_read_b128 v[52:55], v1 offset:17408
s_waitcnt lgkmcnt(7)
v_mfma_f32_16x16x32_bf16 v[192:195], v[72:75], v[56:59], v[192:195]
v_mfma_f32_16x16x32_bf16 v[196:199], v[76:79], v[56:59], v[196:199]
ds_read_b128 v[56:59], v1 offset:31744
s_waitcnt lgkmcnt(7)
v_mfma_f32_16x16x32_bf16 v[200:203], v[72:75], v[60:63], v[200:203]
v_mfma_f32_16x16x32_bf16 v[204:207], v[76:79], v[60:63], v[204:207]
ds_read_b128 v[60:63], v1 offset:46080
s_add_u32 m0, s27, 59392
s_add_u32 s6, s26, 59392
buffer_load_dwordx4 v1, s[52:55], s6 offen sc1 lds
s_waitcnt lgkmcnt(7)
v_mfma_f32_16x16x32_bf16 v[176:179], v[80:83], v[32:35], v[176:179]
v_mfma_f32_16x16x32_bf16 v[180:183], v[84:87], v[32:35], v[180:183]
ds_read_b128 v[32:35], v1 offset:4096
s_add_u32 s9, s18, 20480
buffer_load_dwordx4 v[144:147], v1, s[52:55], s9 offen offset:0 sc1
s_waitcnt lgkmcnt(7)
v_mfma_f32_16x16x32_bf16 v[184:187], v[80:83], v[36:39], v[184:187]
v_mfma_f32_16x16x32_bf16 v[188:191], v[84:87], v[36:39], v[188:191]
ds_read_b128 v[36:39], v1 offset:18432
s_waitcnt lgkmcnt(7)
v_mfma_f32_16x16x32_bf16 v[192:195], v[80:83], v[40:43], v[192:195]
v_mfma_f32_16x16x32_bf16 v[196:199], v[84:87], v[40:43], v[196:199]
ds_read_b128 v[40:43], v1 offset:32768
s_add_u32 s9, s18, 20480
buffer_load_dwordx4 v[148:151], v1, s[52:55], s9 offen offset:1024 sc1
s_waitcnt lgkmcnt(7)
v_mfma_f32_16x16x32_bf16 v[200:203], v[80:83], v[44:47], v[200:203]
v_mfma_f32_16x16x32_bf16 v[204:207], v[84:87], v[44:47], v[204:207]
ds_read_b128 v[44:47], v1 offset:47104
s_add_u32 m0, s27, 61440
s_add_u32 s6, s26, 61440
buffer_load_dwordx4 v1, s[52:55], s6 offen sc1 lds
s_waitcnt lgkmcnt(7)
v_mfma_f32_16x16x32_bf16 v[176:179], v[88:91], v[48:51], v[176:179]
v_mfma_f32_16x16x32_bf16 v[180:183], v[92:95], v[48:51], v[180:183]
ds_read_b128 v[48:51], v1 offset:5120
s_add_u32 s9, s18, 20480
buffer_load_dwordx4 v[152:155], v1, s[52:55], s9 offen offset:2048 sc1
s_waitcnt lgkmcnt(7)
v_mfma_f32_16x16x32_bf16 v[184:187], v[88:91], v[52:55], v[184:187]
v_mfma_f32_16x16x32_bf16 v[188:191], v[92:95], v[52:55], v[188:191]
ds_read_b128 v[52:55], v1 offset:19456
s_waitcnt lgkmcnt(7)
v_mfma_f32_16x16x32_bf16 v[192:195], v[88:91], v[56:59], v[192:195]
v_mfma_f32_16x16x32_bf16 v[196:199], v[92:95], v[56:59], v[196:199]
ds_read_b128 v[56:59], v1 offset:33792
s_add_u32 s9, s18, 20480
buffer_load_dwordx4 v[156:159], v1, s[52:55], s9 offen offset:3072 sc1
s_waitcnt lgkmcnt(7)
v_mfma_f32_16x16x32_bf16 v[200:203], v[88:91], v[60:63], v[200:203]
v_mfma_f32_16x16x32_bf16 v[204:207], v[92:95], v[60:63], v[204:207]
ds_read_b128 v[60:63], v1 offset:48128
s_waitcnt vmcnt(7)
s_barrier
s_add_u32 m0, s27, 63488
s_add_u32 s6, s26, 63488
buffer_load_dwordx4 v1, s[52:55], s6 offen sc1 lds
s_waitcnt lgkmcnt(7)
v_mfma_f32_16x16x32_bf16 v[176:179], v[96:99], v[32:35], v[176:179]
v_mfma_f32_16x16x32_bf16 v[180:183], v[100:103], v[32:35], v[180:183]
ds_read_b128 v[32:35], v1 offset:6144
s_add_u32 s9, s18, 24576
buffer_load_dwordx4 v[160:163], v1, s[52:55], s9 offen offset:0 sc1
s_waitcnt lgkmcnt(7)
v_mfma_f32_16x16x32_bf16 v[184:187], v[96:99], v[36:39], v[184:187]
v_mfma_f32_16x16x32_bf16 v[188:191], v[100:103], v[36:39], v[188:191]
ds_read_b128 v[36:39], v1 offset:20480
s_waitcnt lgkmcnt(7)
v_mfma_f32_16x16x32_bf16 v[192:195], v[96:99], v[40:43], v[192:195]
v_mfma_f32_16x16x32_bf16 v[196:199], v[100:103], v[40:43], v[196:199]
ds_read_b128 v[40:43], v1 offset:34816
s_add_u32 s9, s18, 24576
buffer_load_dwordx4 v[164:167], v1, s[52:55], s9 offen offset:1024 sc1
s_waitcnt lgkmcnt(7)
v_mfma_f32_16x16x32_bf16 v[200:203], v[96:99], v[44:47], v[200:203]
v_mfma_f32_16x16x32_bf16 v[204:207], v[100:103], v[44:47], v[204:207]
ds_read_b128 v[44:47], v1 offset:49152
s_add_u32 m0, s27, 65536
s_add_u32 s6, s26, 65536
buffer_load_dwordx4 v1, s[52:55], s6 offen sc1 lds
s_waitcnt lgkmcnt(7)
v_mfma_f32_16x16x32_bf16 v[176:179], v[104:107], v[48:51], v[176:179]
v_mfma_f32_16x16x32_bf16 v[180:183], v[108:111], v[48:51], v[180:183]
ds_read_b128 v[48:51], v1 offset:7168
s_add_u32 s9, s18, 24576
buffer_load_dwordx4 v[168:171], v1, s[52:55], s9 offen offset:2048 sc1
s_waitcnt lgkmcnt(7)
v_mfma_f32_16x16x32_bf16 v[184:187], v[104:107], v[52:55], v[184:187]
v_mfma_f32_16x16x32_bf16 v[188:191], v[108:111], v[52:55], v[188:191]
ds_read_b128 v[52:55], v1 offset:21504
s_waitcnt lgkmcnt(7)
v_mfma_f32_16x16x32_bf16 v[192:195], v[104:107], v[56:59], v[192:195]
v_mfma_f32_16x16x32_bf16 v[196:199], v[108:111], v[56:59], v[196:199]
ds_read_b128 v[56:59], v1 offset:35840
s_add_u32 s9, s18, 24576
buffer_load_dwordx4 v[172:175], v1, s[52:55], s9 offen offset:3072 sc1
s_waitcnt lgkmcnt(7)
v_mfma_f32_16x16x32_bf16 v[200:203], v[104:107], v[60:63], v[200:203]
v_mfma_f32_16x16x32_bf16 v[204:207], v[108:111], v[60:63], v[204:207]
ds_read_b128 v[60:63], v1 offset:50176
s_add_u32 m0, s27, 67584
s_add_u32 s6, s26, 67584
buffer_load_dwordx4 v1, s[52:55], s6 offen sc1 lds
s_waitcnt lgkmcnt(7)
v_mfma_f32_16x16x32_bf16 v[176:179], v[112:115], v[32:35], v[176:179]
v_mfma_f32_16x16x32_bf16 v[180:183], v[116:119], v[32:35], v[180:183]
ds_read_b128 v[32:35], v1 offset:8192
s_add_u32 m0, s21, 0
s_add_u32 s9, s19, 51200
buffer_load_dwordx4 v1, s[52:55], s9 offen sc1 lds
s_waitcnt lgkmcnt(7)
v_mfma_f32_16x16x32_bf16 v[184:187], v[112:115], v[36:39], v[184:187]
v_mfma_f32_16x16x32_bf16 v[188:191], v[116:119], v[36:39], v[188:191]
ds_read_b128 v[36:39], v1 offset:22528
s_waitcnt lgkmcnt(7)
v_mfma_f32_16x16x32_bf16 v[192:195], v[112:115], v[40:43], v[192:195]
v_mfma_f32_16x16x32_bf16 v[196:199], v[116:119], v[40:43], v[196:199]
ds_read_b128 v[40:43], v1 offset:36864
s_add_u32 m0, s21, 1024
s_add_u32 s9, s19, 52224
buffer_load_dwordx4 v1, s[52:55], s9 offen sc1 lds
s_waitcnt lgkmcnt(7)
v_mfma_f32_16x16x32_bf16 v[200:203], v[112:115], v[44:47], v[200:203]
v_mfma_f32_16x16x32_bf16 v[204:207], v[116:119], v[44:47], v[204:207]
ds_read_b128 v[44:47], v1 offset:51200
s_add_u32 m0, s27, 69632
s_add_u32 s6, s26, 69632
buffer_load_dwordx4 v1, s[52:55], s6 offen sc1 lds
s_waitcnt lgkmcnt(7)
v_mfma_f32_16x16x32_bf16 v[176:179], v[120:123], v[48:51], v[176:179]
v_mfma_f32_16x16x32_bf16 v[180:183], v[124:127], v[48:51], v[180:183]
ds_read_b128 v[48:51], v1 offset:9216
s_add_u32 m0, s21, 2048
s_add_u32 s9, s19, 53248
buffer_load_dwordx4 v1, s[52:55], s9 offen sc1 lds
s_waitcnt lgkmcnt(7)
v_mfma_f32_16x16x32_bf16 v[184:187], v[120:123], v[52:55], v[184:187]
v_mfma_f32_16x16x32_bf16 v[188:191], v[124:127], v[52:55], v[188:191]
ds_read_b128 v[52:55], v1 offset:23552
s_waitcnt lgkmcnt(7)
v_mfma_f32_16x16x32_bf16 v[192:195], v[120:123], v[56:59], v[192:195]
v_mfma_f32_16x16x32_bf16 v[196:199], v[124:127], v[56:59], v[196:199]
ds_read_b128 v[56:59], v1 offset:37888
s_add_u32 m0, s21, 3072
s_add_u32 s9, s19, 54272
buffer_load_dwordx4 v1, s[52:55], s9 offen sc1 lds
s_waitcnt lgkmcnt(7)
v_mfma_f32_16x16x32_bf16 v[200:203], v[120:123], v[60:63], v[200:203]
v_mfma_f32_16x16x32_bf16 v[204:207], v[124:127], v[60:63], v[204:207]
ds_read_b128 v[60:63], v1 offset:52224
s_waitcnt lgkmcnt(7)
v_mfma_f32_16x16x32_bf16 v[176:179], v[128:131], v[32:35], v[176:179]
v_mfma_f32_16x16x32_bf16 v[180:183], v[132:135], v[32:35], v[180:183]
ds_read_b128 v[32:35], v1 offset:10240
s_add_u32 m0, s21, 4096
s_add_u32 s9, s19, 55296
buffer_load_dwordx4 v1, s[52:55], s9 offen sc1 lds
s_waitcnt lgkmcnt(7)
v_mfma_f32_16x16x32_bf16 v[184:187], v[128:131], v[36:39], v[184:187]
v_mfma_f32_16x16x32_bf16 v[188:191], v[132:135], v[36:39], v[188:191]
ds_read_b128 v[36:39], v1 offset:24576
s_waitcnt lgkmcnt(7)
v_mfma_f32_16x16x32_bf16 v[192:195], v[128:131], v[40:43], v[192:195]
v_mfma_f32_16x16x32_bf16 v[196:199], v[132:135], v[40:43], v[196:199]
ds_read_b128 v[40:43], v1 offset:38912
s_add_u32 m0, s21, 5120
s_add_u32 s9, s19, 56320
buffer_load_dwordx4 v1, s[52:55], s9 offen sc1 lds
s_waitcnt lgkmcnt(7)
v_mfma_f32_16x16x32_bf16 v[200:203], v[128:131], v[44:47], v[200:203]
v_mfma_f32_16x16x32_bf16 v[204:207], v[132:135], v[44:47], v[204:207]
ds_read_b128 v[44:47], v1 offset:53248
s_waitcnt lgkmcnt(7)
v_mfma_f32_16x16x32_bf16 v[176:179], v[136:139], v[48:51], v[176:179]
v_mfma_f32_16x16x32_bf16 v[180:183], v[140:143], v[48:51], v[180:183]
ds_read_b128 v[48:51], v1 offset:11264
s_add_u32 s9, s19, 36864
buffer_load_dwordx4 v[208:211], v1, s[52:55], s9 offen offset:0 sc1
s_waitcnt lgkmcnt(7)
v_mfma_f32_16x16x32_bf16 v[184:187], v[136:139], v[52:55], v[184:187]
v_mfma_f32_16x16x32_bf16 v[188:191], v[140:143], v[52:55], v[188:191]
ds_read_b128 v[52:55], v1 offset:25600
s_waitcnt lgkmcnt(7)
v_mfma_f32_16x16x32_bf16 v[192:195], v[136:139], v[56:59], v[192:195]
v_mfma_f32_16x16x32_bf16 v[196:199], v[140:143], v[56:59], v[196:199]
ds_read_b128 v[56:59], v1 offset:39936
s_add_u32 s9, s19, 36864
buffer_load_dwordx4 v[212:215], v1, s[52:55], s9 offen offset:1024 sc1
s_waitcnt lgkmcnt(7)
v_mfma_f32_16x16x32_bf16 v[200:203], v[136:139], v[60:63], v[200:203]
v_mfma_f32_16x16x32_bf16 v[204:207], v[140:143], v[60:63], v[204:207]
ds_read_b128 v[60:63], v1 offset:54272
s_waitcnt vmcnt(20)
s_waitcnt vmcnt(19)
v_mfma_f32_16x16x32_bf16 v[240:243], v[144:147], v[16:19], v[240:243]
v_mfma_f32_16x16x32_bf16 v[244:247], v[148:151], v[16:19], v[244:247]
s_waitcnt lgkmcnt(7)
v_mfma_f32_16x16x32_bf16 v[176:179], v[144:147], v[32:35], v[176:179]
v_mfma_f32_16x16x32_bf16 v[180:183], v[148:151], v[32:35], v[180:183]
ds_read_b128 v[32:35], v1 offset:12288
s_add_u32 s9, s19, 36864
buffer_load_dwordx4 v[216:219], v1, s[52:55], s9 offen offset:2048 sc1
s_waitcnt lgkmcnt(7)
v_mfma_f32_16x16x32_bf16 v[184:187], v[144:147], v[36:39], v[184:187]
v_mfma_f32_16x16x32_bf16 v[188:191], v[148:151], v[36:39], v[188:191]
ds_read_b128 v[36:39], v1 offset:26624
s_waitcnt lgkmcnt(7)
v_mfma_f32_16x16x32_bf16 v[192:195], v[144:147], v[40:43], v[192:195]
v_mfma_f32_16x16x32_bf16 v[196:199], v[148:151], v[40:43], v[196:199]
ds_read_b128 v[40:43], v1 offset:40960
s_add_u32 s9, s19, 36864
buffer_load_dwordx4 v[220:223], v1, s[52:55], s9 offen offset:3072 sc1
s_waitcnt lgkmcnt(7)
v_mfma_f32_16x16x32_bf16 v[200:203], v[144:147], v[44:47], v[200:203]
v_mfma_f32_16x16x32_bf16 v[204:207], v[148:151], v[44:47], v[204:207]
ds_read_b128 v[44:47], v1 offset:55296
s_waitcnt vmcnt(19)
s_waitcnt vmcnt(18)
v_mfma_f32_16x16x32_bf16 v[240:243], v[152:155], v[16:19], v[240:243]
v_mfma_f32_16x16x32_bf16 v[244:247], v[156:159], v[16:19], v[244:247]
s_waitcnt lgkmcnt(7)
v_mfma_f32_16x16x32_bf16 v[176:179], v[152:155], v[48:51], v[176:179]
v_mfma_f32_16x16x32_bf16 v[180:183], v[156:159], v[48:51], v[180:183]
ds_read_b128 v[48:51], v1 offset:13312
s_add_u32 s9, s19, 40960
buffer_load_dwordx4 v[224:227], v1, s[52:55], s9 offen offset:0 sc1
s_waitcnt lgkmcnt(7)
v_mfma_f32_16x16x32_bf16 v[184:187], v[152:155], v[52:55], v[184:187]
v_mfma_f32_16x16x32_bf16 v[188:191], v[156:159], v[52:55], v[188:191]
ds_read_b128 v[52:55], v1 offset:27648
s_waitcnt lgkmcnt(7)
v_mfma_f32_16x16x32_bf16 v[192:195], v[152:155], v[56:59], v[192:195]
v_mfma_f32_16x16x32_bf16 v[196:199], v[156:159], v[56:59], v[196:199]
ds_read_b128 v[56:59], v1 offset:41984
s_add_u32 s9, s19, 40960
buffer_load_dwordx4 v[228:231], v1, s[52:55], s9 offen offset:1024 sc1
s_waitcnt lgkmcnt(7)
v_mfma_f32_16x16x32_bf16 v[200:203], v[152:155], v[60:63], v[200:203]
v_mfma_f32_16x16x32_bf16 v[204:207], v[156:159], v[60:63], v[204:207]
ds_read_b128 v[60:63], v1 offset:56320
s_waitcnt vmcnt(10)
s_barrier
v_mfma_f32_16x16x32_bf16 v[240:243], v[160:163], v[16:19], v[240:243]
v_mfma_f32_16x16x32_bf16 v[244:247], v[164:167], v[16:19], v[244:247]
s_waitcnt lgkmcnt(7)
v_mfma_f32_16x16x32_bf16 v[176:179], v[160:163], v[32:35], v[176:179]
v_mfma_f32_16x16x32_bf16 v[180:183], v[164:167], v[32:35], v[180:183]
ds_read_b128 v[32:35], v2 offset:0
s_add_u32 s9, s19, 40960
buffer_load_dwordx4 v[232:235], v1, s[52:55], s9 offen offset:2048 sc1
s_waitcnt lgkmcnt(7)
v_mfma_f32_16x16x32_bf16 v[184:187], v[160:163], v[36:39], v[184:187]
v_mfma_f32_16x16x32_bf16 v[188:191], v[164:167], v[36:39], v[188:191]
ds_read_b128 v[36:39], v2 offset:14336
s_waitcnt lgkmcnt(7)
v_mfma_f32_16x16x32_bf16 v[192:195], v[160:163], v[40:43], v[192:195]
v_mfma_f32_16x16x32_bf16 v[196:199], v[164:167], v[40:43], v[196:199]
ds_read_b128 v[40:43], v2 offset:28672
s_add_u32 s9, s19, 40960
buffer_load_dwordx4 v[236:239], v1, s[52:55], s9 offen offset:3072 sc1
s_waitcnt lgkmcnt(7)
v_mfma_f32_16x16x32_bf16 v[200:203], v[160:163], v[44:47], v[200:203]
v_mfma_f32_16x16x32_bf16 v[204:207], v[164:167], v[44:47], v[204:207]
ds_read_b128 v[44:47], v2 offset:43008
v_mfma_f32_16x16x32_bf16 v[240:243], v[168:171], v[16:19], v[240:243]
v_mfma_f32_16x16x32_bf16 v[244:247], v[172:175], v[16:19], v[244:247]
s_waitcnt lgkmcnt(7)
v_mfma_f32_16x16x32_bf16 v[176:179], v[168:171], v[48:51], v[176:179]
v_mfma_f32_16x16x32_bf16 v[180:183], v[172:175], v[48:51], v[180:183]
ds_read_b128 v[48:51], v2 offset:1024
s_waitcnt lgkmcnt(7)
v_mfma_f32_16x16x32_bf16 v[184:187], v[168:171], v[52:55], v[184:187]
v_mfma_f32_16x16x32_bf16 v[188:191], v[172:175], v[52:55], v[188:191]
ds_read_b128 v[52:55], v2 offset:15360
s_waitcnt lgkmcnt(7)
v_mfma_f32_16x16x32_bf16 v[192:195], v[168:171], v[56:59], v[192:195]
v_mfma_f32_16x16x32_bf16 v[196:199], v[172:175], v[56:59], v[196:199]
ds_read_b128 v[56:59], v2 offset:29696
s_waitcnt lgkmcnt(7)
v_mfma_f32_16x16x32_bf16 v[200:203], v[168:171], v[60:63], v[200:203]
v_mfma_f32_16x16x32_bf16 v[204:207], v[172:175], v[60:63], v[204:207]
ds_read_b128 v[60:63], v2 offset:44032
s_waitcnt lgkmcnt(0)
s_mov_b32 s10, 0
L66:
ds_read_b32 v12, v11 offset:4
s_add_u32 s10, s10, 1
s_cmp_gt_u32 s10, 0x100000
s_waitcnt lgkmcnt(0)
s_cbranch_scc1 L67
v_cmp_gt_u32 vcc, 1, v12
s_cbranch_vccnz L66
L67:
ds_read_b128 v[28:31], v9 offset:0
ds_read_b128 v[4:7], v9 offset:256
s_waitcnt lgkmcnt(1)
v_fmac_f32 v176, v240, v28
v_fmac_f32 v177, v241, v28
v_fmac_f32 v178, v242, v28
v_fmac_f32 v179, v243, v28
v_fmac_f32 v180, v244, v28
v_fmac_f32 v181, v245, v28
v_fmac_f32 v182, v246, v28
v_fmac_f32 v183, v247, v28
v_mul_f32 v248, v176, v29
v_mul_f32 v249, v177, v29
v_mul_f32 v250, v178, v29
v_mul_f32 v251, v179, v29
v_exp_f32 v248, v248
v_exp_f32 v249, v249
v_exp_f32 v250, v250
v_exp_f32 v251, v251
v_mul_f32 v176, v176, v180
v_mul_f32 v177, v177, v181
v_mul_f32 v178, v178, v182
v_mul_f32 v179, v179, v183
v_fma_f32 v248, v248, v30, v30
v_fma_f32 v249, v249, v30, v30
v_fma_f32 v250, v250, v30, v30
v_fma_f32 v251, v251, v30, v30
ds_read_b128 v[28:31], v9 offset:512
v_rcp_f32 v248, v248
v_rcp_f32 v249, v249
v_rcp_f32 v250, v250
v_rcp_f32 v251, v251
v_mul_f32 v176, v176, v248
v_mul_f32 v177, v177, v249
v_mul_f32 v178, v178, v250
v_mul_f32 v179, v179, v251
v_cvt_pk_bf16_f32 v252, v176, v177
v_cvt_pk_bf16_f32 v253, v178, v179
s_waitcnt lgkmcnt(1)
v_fmac_f32 v184, v240, v4
v_fmac_f32 v185, v241, v4
v_fmac_f32 v186, v242, v4
v_fmac_f32 v187, v243, v4
v_fmac_f32 v188, v244, v4
v_fmac_f32 v189, v245, v4
v_fmac_f32 v190, v246, v4
v_fmac_f32 v191, v247, v4
v_mul_f32 v248, v184, v5
v_mul_f32 v249, v185, v5
v_mul_f32 v250, v186, v5
v_mul_f32 v251, v187, v5
v_exp_f32 v248, v248
v_exp_f32 v249, v249
v_exp_f32 v250, v250
v_exp_f32 v251, v251
v_mul_f32 v184, v184, v188
v_mul_f32 v185, v185, v189
v_mul_f32 v186, v186, v190
v_mul_f32 v187, v187, v191
v_fma_f32 v248, v248, v6, v6
v_fma_f32 v249, v249, v6, v6
v_fma_f32 v250, v250, v6, v6
v_fma_f32 v251, v251, v6, v6
ds_read_b128 v[4:7], v9 offset:768
v_rcp_f32 v248, v248
v_rcp_f32 v249, v249
v_rcp_f32 v250, v250
v_rcp_f32 v251, v251
v_mul_f32 v184, v184, v248
v_mul_f32 v185, v185, v249
v_mul_f32 v186, v186, v250
v_mul_f32 v187, v187, v251
v_cvt_pk_bf16_f32 v254, v184, v185
v_cvt_pk_bf16_f32 v255, v186, v187
s_add_u32 s4, s20, 0
v_permlane16_swap_b32 v252, v254
v_permlane16_swap_b32 v253, v255
buffer_store_dwordx4 v[252:255], v8, s[52:55], s4 offen sc1
s_waitcnt lgkmcnt(1)
v_fmac_f32 v192, v240, v28
v_fmac_f32 v193, v241, v28
v_fmac_f32 v194, v242, v28
v_fmac_f32 v195, v243, v28
v_fmac_f32 v196, v244, v28
v_fmac_f32 v197, v245, v28
v_fmac_f32 v198, v246, v28
v_fmac_f32 v199, v247, v28
v_mul_f32 v248, v192, v29
v_mul_f32 v249, v193, v29
v_mul_f32 v250, v194, v29
v_mul_f32 v251, v195, v29
v_exp_f32 v248, v248
v_exp_f32 v249, v249
v_exp_f32 v250, v250
v_exp_f32 v251, v251
v_mul_f32 v192, v192, v196
v_mul_f32 v193, v193, v197
v_mul_f32 v194, v194, v198
v_mul_f32 v195, v195, v199
v_fma_f32 v248, v248, v30, v30
v_fma_f32 v249, v249, v30, v30
v_fma_f32 v250, v250, v30, v30
v_fma_f32 v251, v251, v30, v30
v_rcp_f32 v248, v248
v_rcp_f32 v249, v249
v_rcp_f32 v250, v250
v_rcp_f32 v251, v251
v_mul_f32 v192, v192, v248
v_mul_f32 v193, v193, v249
v_mul_f32 v194, v194, v250
v_mul_f32 v195, v195, v251
v_cvt_pk_bf16_f32 v16, v192, v193
v_cvt_pk_bf16_f32 v17, v194, v195
s_waitcnt lgkmcnt(0)
v_fmac_f32 v200, v240, v4
v_fmac_f32 v201, v241, v4
v_fmac_f32 v202, v242, v4
v_fmac_f32 v203, v243, v4
v_fmac_f32 v204, v244, v4
v_fmac_f32 v205, v245, v4
v_fmac_f32 v206, v246, v4
v_fmac_f32 v207, v247, v4
v_mul_f32 v248, v200, v5
v_mul_f32 v249, v201, v5
v_mul_f32 v250, v202, v5
v_mul_f32 v251, v203, v5
v_exp_f32 v248, v248
v_exp_f32 v249, v249
v_exp_f32 v250, v250
v_exp_f32 v251, v251
v_mul_f32 v200, v200, v204
v_mul_f32 v201, v201, v205
v_mul_f32 v202, v202, v206
v_mul_f32 v203, v203, v207
v_fma_f32 v248, v248, v6, v6
v_fma_f32 v249, v249, v6, v6
v_fma_f32 v250, v250, v6, v6
v_fma_f32 v251, v251, v6, v6
v_rcp_f32 v248, v248
v_rcp_f32 v249, v249
v_rcp_f32 v250, v250
v_rcp_f32 v251, v251
v_mul_f32 v200, v200, v248
v_mul_f32 v201, v201, v249
v_mul_f32 v202, v202, v250
v_mul_f32 v203, v203, v251
v_cvt_pk_bf16_f32 v18, v200, v201
v_cvt_pk_bf16_f32 v19, v202, v203
s_add_u32 s4, s20, 114688
v_permlane16_swap_b32 v16, v18
v_permlane16_swap_b32 v17, v19
buffer_store_dwordx4 v[16:19], v8, s[52:55], s4 offen sc1
v_mfma_f32_16x16x32_bf16 v[176:179], v[64:67], v[32:35], 0
v_mfma_f32_16x16x32_bf16 v[180:183], v[68:71], v[32:35], 0
ds_read_b128 v[32:35], v2 offset:2048
v_mfma_f32_16x16x32_bf16 v[184:187], v[64:67], v[36:39], 0
v_mfma_f32_16x16x32_bf16 v[188:191], v[68:71], v[36:39], 0
ds_read_b128 v[36:39], v2 offset:16384
v_mfma_f32_16x16x32_bf16 v[192:195], v[64:67], v[40:43], 0
v_mfma_f32_16x16x32_bf16 v[196:199], v[68:71], v[40:43], 0
ds_read_b128 v[40:43], v2 offset:30720
v_mfma_f32_16x16x32_bf16 v[200:203], v[64:67], v[44:47], 0
v_mfma_f32_16x16x32_bf16 v[204:207], v[68:71], v[44:47], 0
ds_read_b128 v[44:47], v2 offset:45056
v_mfma_f32_16x16x32_bf16 v[176:179], v[72:75], v[48:51], v[176:179]
v_mfma_f32_16x16x32_bf16 v[180:183], v[76:79], v[48:51], v[180:183]
ds_read_b128 v[48:51], v2 offset:3072
v_mfma_f32_16x16x32_bf16 v[184:187], v[72:75], v[52:55], v[184:187]
v_mfma_f32_16x16x32_bf16 v[188:191], v[76:79], v[52:55], v[188:191]
ds_read_b128 v[52:55], v2 offset:17408
v_mfma_f32_16x16x32_bf16 v[192:195], v[72:75], v[56:59], v[192:195]
v_mfma_f32_16x16x32_bf16 v[196:199], v[76:79], v[56:59], v[196:199]
ds_read_b128 v[56:59], v2 offset:31744
v_mfma_f32_16x16x32_bf16 v[200:203], v[72:75], v[60:63], v[200:203]
v_mfma_f32_16x16x32_bf16 v[204:207], v[76:79], v[60:63], v[204:207]
ds_read_b128 v[60:63], v2 offset:46080
s_waitcnt lgkmcnt(7)
v_mfma_f32_16x16x32_bf16 v[176:179], v[80:83], v[32:35], v[176:179]
v_mfma_f32_16x16x32_bf16 v[180:183], v[84:87], v[32:35], v[180:183]
ds_read_b128 v[32:35], v2 offset:4096
s_waitcnt lgkmcnt(7)
v_mfma_f32_16x16x32_bf16 v[184:187], v[80:83], v[36:39], v[184:187]
v_mfma_f32_16x16x32_bf16 v[188:191], v[84:87], v[36:39], v[188:191]
ds_read_b128 v[36:39], v2 offset:18432
s_waitcnt lgkmcnt(7)
v_mfma_f32_16x16x32_bf16 v[192:195], v[80:83], v[40:43], v[192:195]
v_mfma_f32_16x16x32_bf16 v[196:199], v[84:87], v[40:43], v[196:199]
ds_read_b128 v[40:43], v2 offset:32768
s_waitcnt lgkmcnt(7)
v_mfma_f32_16x16x32_bf16 v[200:203], v[80:83], v[44:47], v[200:203]
v_mfma_f32_16x16x32_bf16 v[204:207], v[84:87], v[44:47], v[204:207]
ds_read_b128 v[44:47], v2 offset:47104
s_waitcnt vmcnt(0)
s_waitcnt lgkmcnt(0)
v_mov_b32 v12, 1
s_mov_b64 exec, 1
ds_add_rtn_u32 v12, v11, v12 offset:8
s_waitcnt lgkmcnt(0)
v_readfirstlane_b32 s5, v12
s_nop 0
s_cmp_lg_u32 s5, 6
s_cbranch_scc1 L68
s_lshl_b32 s4, s33, 7
s_add_u32 s5, s4, 0x98000
buffer_store_dwordx2 v[24:25], v1, s[52:55], s5 offen
s_add_u32 s5, s4, 0x18000
buffer_store_dwordx2 v[24:25], v1, s[52:55], s5 offen sc1
L68:
s_mov_b64 exec, -1
v_mfma_f32_16x16x32_bf16 v[176:179], v[88:91], v[48:51], v[176:179]
v_mfma_f32_16x16x32_bf16 v[180:183], v[92:95], v[48:51], v[180:183]
ds_read_b128 v[48:51], v2 offset:5120
buffer_load_dwordx4 v[64:67], v1, s[52:55], s19 offen offset:0 sc1
v_mfma_f32_16x16x32_bf16 v[184:187], v[88:91], v[52:55], v[184:187]
v_mfma_f32_16x16x32_bf16 v[188:191], v[92:95], v[52:55], v[188:191]
ds_read_b128 v[52:55], v2 offset:19456
v_mfma_f32_16x16x32_bf16 v[192:195], v[88:91], v[56:59], v[192:195]
v_mfma_f32_16x16x32_bf16 v[196:199], v[92:95], v[56:59], v[196:199]
ds_read_b128 v[56:59], v2 offset:33792
buffer_load_dwordx4 v[68:71], v1, s[52:55], s19 offen offset:1024 sc1
v_mfma_f32_16x16x32_bf16 v[200:203], v[88:91], v[60:63], v[200:203]
v_mfma_f32_16x16x32_bf16 v[204:207], v[92:95], v[60:63], v[204:207]
ds_read_b128 v[60:63], v2 offset:48128
v_mfma_f32_16x16x32_bf16 v[176:179], v[96:99], v[32:35], v[176:179]
v_mfma_f32_16x16x32_bf16 v[180:183], v[100:103], v[32:35], v[180:183]
ds_read_b128 v[32:35], v2 offset:6144
buffer_load_dwordx4 v[72:75], v1, s[52:55], s19 offen offset:2048 sc1
v_mfma_f32_16x16x32_bf16 v[184:187], v[96:99], v[36:39], v[184:187]
v_mfma_f32_16x16x32_bf16 v[188:191], v[100:103], v[36:39], v[188:191]
ds_read_b128 v[36:39], v2 offset:20480
v_mfma_f32_16x16x32_bf16 v[192:195], v[96:99], v[40:43], v[192:195]
v_mfma_f32_16x16x32_bf16 v[196:199], v[100:103], v[40:43], v[196:199]
ds_read_b128 v[40:43], v2 offset:34816
buffer_load_dwordx4 v[76:79], v1, s[52:55], s19 offen offset:3072 sc1
v_mfma_f32_16x16x32_bf16 v[200:203], v[96:99], v[44:47], v[200:203]
v_mfma_f32_16x16x32_bf16 v[204:207], v[100:103], v[44:47], v[204:207]
ds_read_b128 v[44:47], v2 offset:49152
s_waitcnt lgkmcnt(7)
v_mfma_f32_16x16x32_bf16 v[176:179], v[104:107], v[48:51], v[176:179]
v_mfma_f32_16x16x32_bf16 v[180:183], v[108:111], v[48:51], v[180:183]
ds_read_b128 v[48:51], v2 offset:7168
s_add_u32 s9, s19, 4096
buffer_load_dwordx4 v[80:83], v1, s[52:55], s9 offen offset:0 sc1
s_waitcnt lgkmcnt(7)
v_mfma_f32_16x16x32_bf16 v[184:187], v[104:107], v[52:55], v[184:187]
v_mfma_f32_16x16x32_bf16 v[188:191], v[108:111], v[52:55], v[188:191]
ds_read_b128 v[52:55], v2 offset:21504
s_waitcnt lgkmcnt(7)
v_mfma_f32_16x16x32_bf16 v[192:195], v[104:107], v[56:59], v[192:195]
v_mfma_f32_16x16x32_bf16 v[196:199], v[108:111], v[56:59], v[196:199]
ds_read_b128 v[56:59], v2 offset:35840
s_add_u32 s9, s19, 4096
buffer_load_dwordx4 v[84:87], v1, s[52:55], s9 offen offset:1024 sc1
s_waitcnt lgkmcnt(7)
v_mfma_f32_16x16x32_bf16 v[200:203], v[104:107], v[60:63], v[200:203]
v_mfma_f32_16x16x32_bf16 v[204:207], v[108:111], v[60:63], v[204:207]
ds_read_b128 v[60:63], v2 offset:50176
s_waitcnt lgkmcnt(7)
v_mfma_f32_16x16x32_bf16 v[176:179], v[112:115], v[32:35], v[176:179]
v_mfma_f32_16x16x32_bf16 v[180:183], v[116:119], v[32:35], v[180:183]
ds_read_b128 v[32:35], v2 offset:8192
s_add_u32 s9, s19, 4096
buffer_load_dwordx4 v[88:91], v1, s[52:55], s9 offen offset:2048 sc1
s_waitcnt lgkmcnt(7)
v_mfma_f32_16x16x32_bf16 v[184:187], v[112:115], v[36:39], v[184:187]
v_mfma_f32_16x16x32_bf16 v[188:191], v[116:119], v[36:39], v[188:191]
ds_read_b128 v[36:39], v2 offset:22528
s_waitcnt lgkmcnt(7)
v_mfma_f32_16x16x32_bf16 v[192:195], v[112:115], v[40:43], v[192:195]
v_mfma_f32_16x16x32_bf16 v[196:199], v[116:119], v[40:43], v[196:199]
ds_read_b128 v[40:43], v2 offset:36864
s_add_u32 s9, s19, 4096
buffer_load_dwordx4 v[92:95], v1, s[52:55], s9 offen offset:3072 sc1
s_waitcnt lgkmcnt(7)
v_mfma_f32_16x16x32_bf16 v[200:203], v[112:115], v[44:47], v[200:203]
v_mfma_f32_16x16x32_bf16 v[204:207], v[116:119], v[44:47], v[204:207]
ds_read_b128 v[44:47], v2 offset:51200
s_waitcnt lgkmcnt(7)
v_mfma_f32_16x16x32_bf16 v[176:179], v[120:123], v[48:51], v[176:179]
v_mfma_f32_16x16x32_bf16 v[180:183], v[124:127], v[48:51], v[180:183]
ds_read_b128 v[48:51], v2 offset:9216
s_add_u32 s9, s19, 8192
buffer_load_dwordx4 v[96:99], v1, s[52:55], s9 offen offset:0 sc1
s_waitcnt lgkmcnt(7)
v_mfma_f32_16x16x32_bf16 v[184:187], v[120:123], v[52:55], v[184:187]
v_mfma_f32_16x16x32_bf16 v[188:191], v[124:127], v[52:55], v[188:191]
ds_read_b128 v[52:55], v2 offset:23552
s_waitcnt lgkmcnt(7)
v_mfma_f32_16x16x32_bf16 v[192:195], v[120:123], v[56:59], v[192:195]
v_mfma_f32_16x16x32_bf16 v[196:199], v[124:127], v[56:59], v[196:199]
ds_read_b128 v[56:59], v2 offset:37888
s_add_u32 s9, s19, 8192
buffer_load_dwordx4 v[100:103], v1, s[52:55], s9 offen offset:1024 sc1
s_waitcnt lgkmcnt(7)
v_mfma_f32_16x16x32_bf16 v[200:203], v[120:123], v[60:63], v[200:203]
v_mfma_f32_16x16x32_bf16 v[204:207], v[124:127], v[60:63], v[204:207]
ds_read_b128 v[60:63], v2 offset:52224
s_waitcnt lgkmcnt(7)
v_mfma_f32_16x16x32_bf16 v[176:179], v[128:131], v[32:35], v[176:179]
v_mfma_f32_16x16x32_bf16 v[180:183], v[132:135], v[32:35], v[180:183]
ds_read_b128 v[32:35], v2 offset:10240
s_add_u32 s9, s19, 8192
buffer_load_dwordx4 v[104:107], v1, s[52:55], s9 offen offset:2048 sc1
s_waitcnt lgkmcnt(7)
v_mfma_f32_16x16x32_bf16 v[184:187], v[128:131], v[36:39], v[184:187]
v_mfma_f32_16x16x32_bf16 v[188:191], v[132:135], v[36:39], v[188:191]
ds_read_b128 v[36:39], v2 offset:24576
s_waitcnt lgkmcnt(7)
v_mfma_f32_16x16x32_bf16 v[192:195], v[128:131], v[40:43], v[192:195]
v_mfma_f32_16x16x32_bf16 v[196:199], v[132:135], v[40:43], v[196:199]
ds_read_b128 v[40:43], v2 offset:38912
s_add_u32 s9, s19, 8192
buffer_load_dwordx4 v[108:111], v1, s[52:55], s9 offen offset:3072 sc1
s_waitcnt lgkmcnt(7)
v_mfma_f32_16x16x32_bf16 v[200:203], v[128:131], v[44:47], v[200:203]
v_mfma_f32_16x16x32_bf16 v[204:207], v[132:135], v[44:47], v[204:207]
ds_read_b128 v[44:47], v2 offset:53248
s_waitcnt lgkmcnt(7)
v_mfma_f32_16x16x32_bf16 v[176:179], v[136:139], v[48:51], v[176:179]
v_mfma_f32_16x16x32_bf16 v[180:183], v[140:143], v[48:51], v[180:183]
ds_read_b128 v[48:51], v2 offset:11264
s_add_u32 s9, s19, 12288
buffer_load_dwordx4 v[112:115], v1, s[52:55], s9 offen offset:0 sc1
s_waitcnt lgkmcnt(7)
v_mfma_f32_16x16x32_bf16 v[184:187], v[136:139], v[52:55], v[184:187]
v_mfma_f32_16x16x32_bf16 v[188:191], v[140:143], v[52:55], v[188:191]
ds_read_b128 v[52:55], v2 offset:25600
s_waitcnt lgkmcnt(7)
v_mfma_f32_16x16x32_bf16 v[192:195], v[136:139], v[56:59], v[192:195]
v_mfma_f32_16x16x32_bf16 v[196:199], v[140:143], v[56:59], v[196:199]
ds_read_b128 v[56:59], v2 offset:39936
s_add_u32 s9, s19, 12288
buffer_load_dwordx4 v[116:119], v1, s[52:55], s9 offen offset:1024 sc1
s_waitcnt lgkmcnt(7)
v_mfma_f32_16x16x32_bf16 v[200:203], v[136:139], v[60:63], v[200:203]
v_mfma_f32_16x16x32_bf16 v[204:207], v[140:143], v[60:63], v[204:207]
ds_read_b128 v[60:63], v2 offset:54272
s_waitcnt lgkmcnt(7)
v_mfma_f32_16x16x32_bf16 v[176:179], v[144:147], v[32:35], v[176:179]
v_mfma_f32_16x16x32_bf16 v[180:183], v[148:151], v[32:35], v[180:183]
ds_read_b128 v[32:35], v2 offset:12288
s_add_u32 s9, s19, 12288
buffer_load_dwordx4 v[120:123], v1, s[52:55], s9 offen offset:2048 sc1
s_waitcnt lgkmcnt(7)
v_mfma_f32_16x16x32_bf16 v[184:187], v[144:147], v[36:39], v[184:187]
v_mfma_f32_16x16x32_bf16 v[188:191], v[148:151], v[36:39], v[188:191]
ds_read_b128 v[36:39], v2 offset:26624
s_waitcnt lgkmcnt(7)
v_mfma_f32_16x16x32_bf16 v[192:195], v[144:147], v[40:43], v[192:195]
v_mfma_f32_16x16x32_bf16 v[196:199], v[148:151], v[40:43], v[196:199]
ds_read_b128 v[40:43], v2 offset:40960
s_add_u32 s9, s19, 12288
buffer_load_dwordx4 v[124:127], v1, s[52:55], s9 offen offset:3072 sc1
s_waitcnt lgkmcnt(7)
v_mfma_f32_16x16x32_bf16 v[200:203], v[144:147], v[44:47], v[200:203]
v_mfma_f32_16x16x32_bf16 v[204:207], v[148:151], v[44:47], v[204:207]
ds_read_b128 v[44:47], v2 offset:55296
s_waitcnt lgkmcnt(7)
v_mfma_f32_16x16x32_bf16 v[176:179], v[152:155], v[48:51], v[176:179]
v_mfma_f32_16x16x32_bf16 v[180:183], v[156:159], v[48:51], v[180:183]
ds_read_b128 v[48:51], v2 offset:13312
s_add_u32 s9, s19, 16384
buffer_load_dwordx4 v[128:131], v1, s[52:55], s9 offen offset:0 sc1
s_waitcnt lgkmcnt(7)
v_mfma_f32_16x16x32_bf16 v[184:187], v[152:155], v[52:55], v[184:187]
v_mfma_f32_16x16x32_bf16 v[188:191], v[156:159], v[52:55], v[188:191]
ds_read_b128 v[52:55], v2 offset:27648
s_waitcnt lgkmcnt(7)
v_mfma_f32_16x16x32_bf16 v[192:195], v[152:155], v[56:59], v[192:195]
v_mfma_f32_16x16x32_bf16 v[196:199], v[156:159], v[56:59], v[196:199]
ds_read_b128 v[56:59], v2 offset:41984
s_add_u32 s9, s19, 16384
buffer_load_dwordx4 v[132:135], v1, s[52:55], s9 offen offset:1024 sc1
s_waitcnt lgkmcnt(7)
v_mfma_f32_16x16x32_bf16 v[200:203], v[152:155], v[60:63], v[200:203]
v_mfma_f32_16x16x32_bf16 v[204:207], v[156:159], v[60:63], v[204:207]
ds_read_b128 v[60:63], v2 offset:56320
s_waitcnt lgkmcnt(7)
v_mfma_f32_16x16x32_bf16 v[176:179], v[160:163], v[32:35], v[176:179]
v_mfma_f32_16x16x32_bf16 v[180:183], v[164:167], v[32:35], v[180:183]
s_add_u32 s9, s19, 16384
buffer_load_dwordx4 v[136:139], v1, s[52:55], s9 offen offset:2048 sc1
s_waitcnt lgkmcnt(6)
v_mfma_f32_16x16x32_bf16 v[184:187], v[160:163], v[36:39], v[184:187]
v_mfma_f32_16x16x32_bf16 v[188:191], v[164:167], v[36:39], v[188:191]
s_waitcnt lgkmcnt(5)
v_mfma_f32_16x16x32_bf16 v[192:195], v[160:163], v[40:43], v[192:195]
v_mfma_f32_16x16x32_bf16 v[196:199], v[164:167], v[40:43], v[196:199]
s_add_u32 s9, s19, 16384
buffer_load_dwordx4 v[140:143], v1, s[52:55], s9 offen offset:3072 sc1
s_waitcnt lgkmcnt(4)
v_mfma_f32_16x16x32_bf16 v[200:203], v[160:163], v[44:47], v[200:203]
v_mfma_f32_16x16x32_bf16 v[204:207], v[164:167], v[44:47], v[204:207]
s_waitcnt lgkmcnt(3)
v_mfma_f32_16x16x32_bf16 v[176:179], v[168:171], v[48:51], v[176:179]
v_mfma_f32_16x16x32_bf16 v[180:183], v[172:175], v[48:51], v[180:183]
s_add_u32 s9, s19, 20480
buffer_load_dwordx4 v[144:147], v1, s[52:55], s9 offen offset:0 sc1
s_waitcnt lgkmcnt(2)
v_mfma_f32_16x16x32_bf16 v[184:187], v[168:171], v[52:55], v[184:187]
v_mfma_f32_16x16x32_bf16 v[188:191], v[172:175], v[52:55], v[188:191]
s_waitcnt lgkmcnt(1)
v_mfma_f32_16x16x32_bf16 v[192:195], v[168:171], v[56:59], v[192:195]
v_mfma_f32_16x16x32_bf16 v[196:199], v[172:175], v[56:59], v[196:199]
s_add_u32 s9, s19, 20480
buffer_load_dwordx4 v[148:151], v1, s[52:55], s9 offen offset:1024 sc1
s_waitcnt lgkmcnt(0)
v_mfma_f32_16x16x32_bf16 v[200:203], v[168:171], v[60:63], v[200:203]
v_mfma_f32_16x16x32_bf16 v[204:207], v[172:175], v[60:63], v[204:207]
s_waitcnt lgkmcnt(0)
s_mov_b32 s10, 0
L69:
ds_read_b32 v12, v11 offset:4
s_add_u32 s10, s10, 1
s_cmp_gt_u32 s10, 0x100000
s_waitcnt lgkmcnt(0)
s_cbranch_scc1 L70
v_cmp_gt_u32 vcc, 2, v12
s_cbranch_vccnz L69
L70:
ds_read_b128 v[28:31], v9 offset:1024
ds_read_b128 v[4:7], v9 offset:1280
s_waitcnt lgkmcnt(1)
v_fmac_f32 v176, v240, v28
v_fmac_f32 v177, v241, v28
v_fmac_f32 v178, v242, v28
v_fmac_f32 v179, v243, v28
v_fmac_f32 v180, v244, v28
v_fmac_f32 v181, v245, v28
v_fmac_f32 v182, v246, v28
v_fmac_f32 v183, v247, v28
v_mul_f32 v248, v176, v29
v_mul_f32 v249, v177, v29
v_mul_f32 v250, v178, v29
v_mul_f32 v251, v179, v29
v_exp_f32 v248, v248
v_exp_f32 v249, v249
v_exp_f32 v250, v250
v_exp_f32 v251, v251
v_mul_f32 v176, v176, v180
v_mul_f32 v177, v177, v181
v_mul_f32 v178, v178, v182
v_mul_f32 v179, v179, v183
v_fma_f32 v248, v248, v30, v30
v_fma_f32 v249, v249, v30, v30
v_fma_f32 v250, v250, v30, v30
v_fma_f32 v251, v251, v30, v30
ds_read_b128 v[28:31], v9 offset:1536
v_rcp_f32 v248, v248
v_rcp_f32 v249, v249
v_rcp_f32 v250, v250
v_rcp_f32 v251, v251
v_mul_f32 v176, v176, v248
v_mul_f32 v177, v177, v249
v_mul_f32 v178, v178, v250
v_mul_f32 v179, v179, v251
v_cvt_pk_bf16_f32 v252, v176, v177
v_cvt_pk_bf16_f32 v253, v178, v179
s_waitcnt lgkmcnt(1)
v_fmac_f32 v184, v240, v4
v_fmac_f32 v185, v241, v4
v_fmac_f32 v186, v242, v4
v_fmac_f32 v187, v243, v4
v_fmac_f32 v188, v244, v4
v_fmac_f32 v189, v245, v4
v_fmac_f32 v190, v246, v4
v_fmac_f32 v191, v247, v4
v_mul_f32 v248, v184, v5
v_mul_f32 v249, v185, v5
v_mul_f32 v250, v186, v5
v_mul_f32 v251, v187, v5
v_exp_f32 v248, v248
v_exp_f32 v249, v249
v_exp_f32 v250, v250
v_exp_f32 v251, v251
v_mul_f32 v184, v184, v188
v_mul_f32 v185, v185, v189
v_mul_f32 v186, v186, v190
v_mul_f32 v187, v187, v191
v_fma_f32 v248, v248, v6, v6
v_fma_f32 v249, v249, v6, v6
v_fma_f32 v250, v250, v6, v6
v_fma_f32 v251, v251, v6, v6
ds_read_b128 v[4:7], v9 offset:1792
v_rcp_f32 v248, v248
v_rcp_f32 v249, v249
v_rcp_f32 v250, v250
v_rcp_f32 v251, v251
v_mul_f32 v184, v184, v248
v_mul_f32 v185, v185, v249
v_mul_f32 v186, v186, v250
v_mul_f32 v187, v187, v251
v_cvt_pk_bf16_f32 v254, v184, v185
v_cvt_pk_bf16_f32 v255, v186, v187
s_add_u32 s4, s20, 229376
v_permlane16_swap_b32 v252, v254
v_permlane16_swap_b32 v253, v255
buffer_store_dwordx4 v[252:255], v8, s[52:55], s4 offen sc1
s_waitcnt lgkmcnt(1)
v_fmac_f32 v192, v240, v28
v_fmac_f32 v193, v241, v28
v_fmac_f32 v194, v242, v28
v_fmac_f32 v195, v243, v28
v_fmac_f32 v196, v244, v28
v_fmac_f32 v197, v245, v28
v_fmac_f32 v198, v246, v28
v_fmac_f32 v199, v247, v28
v_mul_f32 v248, v192, v29
v_mul_f32 v249, v193, v29
v_mul_f32 v250, v194, v29
v_mul_f32 v251, v195, v29
v_exp_f32 v248, v248
v_exp_f32 v249, v249
v_exp_f32 v250, v250
v_exp_f32 v251, v251
v_mul_f32 v192, v192, v196
v_mul_f32 v193, v193, v197
v_mul_f32 v194, v194, v198
v_mul_f32 v195, v195, v199
v_fma_f32 v248, v248, v30, v30
v_fma_f32 v249, v249, v30, v30
v_fma_f32 v250, v250, v30, v30
v_fma_f32 v251, v251, v30, v30
v_rcp_f32 v248, v248
v_rcp_f32 v249, v249
v_rcp_f32 v250, v250
v_rcp_f32 v251, v251
v_mul_f32 v192, v192, v248
v_mul_f32 v193, v193, v249
v_mul_f32 v194, v194, v250
v_mul_f32 v195, v195, v251
v_cvt_pk_bf16_f32 v16, v192, v193
v_cvt_pk_bf16_f32 v17, v194, v195
s_waitcnt lgkmcnt(0)
v_fmac_f32 v200, v240, v4
v_fmac_f32 v201, v241, v4
v_fmac_f32 v202, v242, v4
v_fmac_f32 v203, v243, v4
v_fmac_f32 v204, v244, v4
v_fmac_f32 v205, v245, v4
v_fmac_f32 v206, v246, v4
v_fmac_f32 v207, v247, v4
v_mul_f32 v248, v200, v5
v_mul_f32 v249, v201, v5
v_mul_f32 v250, v202, v5
v_mul_f32 v251, v203, v5
v_exp_f32 v248, v248
v_exp_f32 v249, v249
v_exp_f32 v250, v250
v_exp_f32 v251, v251
v_mul_f32 v200, v200, v204
v_mul_f32 v201, v201, v205
v_mul_f32 v202, v202, v206
v_mul_f32 v203, v203, v207
v_fma_f32 v248, v248, v6, v6
v_fma_f32 v249, v249, v6, v6
v_fma_f32 v250, v250, v6, v6
v_fma_f32 v251, v251, v6, v6
v_rcp_f32 v248, v248
v_rcp_f32 v249, v249
v_rcp_f32 v250, v250
v_rcp_f32 v251, v251
v_mul_f32 v200, v200, v248
v_mul_f32 v201, v201, v249
v_mul_f32 v202, v202, v250
v_mul_f32 v203, v203, v251
v_cvt_pk_bf16_f32 v18, v200, v201
v_cvt_pk_bf16_f32 v19, v202, v203
s_add_u32 s4, s20, 344064
v_permlane16_swap_b32 v16, v18
v_permlane16_swap_b32 v17, v19
buffer_store_dwordx4 v[16:19], v8, s[52:55], s4 offen sc1
s_waitcnt vmcnt(0)
s_waitcnt lgkmcnt(0)
v_mov_b32 v12, 1
s_mov_b64 exec, 1
ds_add_rtn_u32 v12, v11, v12 offset:12
s_waitcnt lgkmcnt(0)
v_readfirstlane_b32 s5, v12
s_nop 0
s_cmp_lg_u32 s5, 6
s_cbranch_scc1 L71
s_lshl_b32 s4, s33, 7
s_add_u32 s5, s4, 0xa8000
buffer_store_dwordx2 v[24:25], v1, s[52:55], s5 offen
s_add_u32 s5, s4, 0x28000
buffer_store_dwordx2 v[24:25], v1, s[52:55], s5 offen sc1
L71:
s_mov_b64 exec, -1
s_add_u32 s9, s19, 20480
buffer_load_dwordx4 v[152:155], v1, s[52:55], s9 offen offset:2048 sc1
s_add_u32 s9, s19, 20480
buffer_load_dwordx4 v[156:159], v1, s[52:55], s9 offen offset:3072 sc1
s_add_u32 s9, s19, 24576
buffer_load_dwordx4 v[160:163], v1, s[52:55], s9 offen offset:0 sc1
s_add_u32 s9, s19, 24576
buffer_load_dwordx4 v[164:167], v1, s[52:55], s9 offen offset:1024 sc1
s_barrier
v_add_u32 v9, s21, v1
ds_read_b128 v[16:19], v9 offset:0
ds_read_b128 v[28:31], v9 offset:1024
ds_read_b128 v[4:7], v9 offset:2048
ds_read_b128 v[32:35], v1 offset:51200
ds_read_b128 v[36:39], v1 offset:52224
ds_read_b128 v[40:43], v1 offset:53248
ds_read_b128 v[44:47], v1 offset:54272
s_waitcnt lgkmcnt(6)
s_waitcnt lgkmcnt(3)
v_mfma_f32_16x16x32_bf16 v[48:51], v[16:19], v[32:35], 0
ds_read_b128 v[16:19], v9 offset:3072
s_add_u32 s9, s19, 24576
buffer_load_dwordx4 v[168:171], v1, s[52:55], s9 offen offset:2048 sc1
ds_read_b128 v[32:35], v1 offset:55296
s_waitcnt lgkmcnt(4)
v_mfma_f32_16x16x32_bf16 v[48:51], v[28:31], v[36:39], v[48:51]
ds_read_b128 v[28:31], v9 offset:4096
s_add_u32 s9, s19, 24576
buffer_load_dwordx4 v[172:175], v1, s[52:55], s9 offen offset:3072 sc1
ds_read_b128 v[36:39], v1 offset:56320
s_waitcnt lgkmcnt(5)
v_mfma_f32_16x16x32_bf16 v[48:51], v[4:7], v[40:43], v[48:51]
ds_read_b128 v[4:7], v9 offset:5120
s_add_u32 s9, s19, 28672
buffer_load_dwordx4 v[176:179], v1, s[52:55], s9 offen offset:0 sc1
ds_read_b128 v[40:43], v1 offset:0
s_waitcnt lgkmcnt(5)
v_mfma_f32_16x16x32_bf16 v[48:51], v[16:19], v[44:47], v[48:51]
s_add_u32 s9, s19, 28672
buffer_load_dwordx4 v[180:183], v1, s[52:55], s9 offen offset:1024 sc1
ds_read_b128 v[44:47], v1 offset:1024
s_waitcnt lgkmcnt(4)
v_mfma_f32_16x16x32_bf16 v[48:51], v[28:31], v[32:35], v[48:51]
s_add_u32 s9, s19, 28672
buffer_load_dwordx4 v[184:187], v1, s[52:55], s9 offen offset:2048 sc1
ds_read_b128 v[32:35], v1 offset:2048
s_waitcnt lgkmcnt(3)
v_mfma_f32_16x16x32_bf16 v[48:51], v[4:7], v[36:39], v[48:51]
s_add_u32 s9, s19, 28672
buffer_load_dwordx4 v[188:191], v1, s[52:55], s9 offen offset:3072 sc1
ds_read_b128 v[36:39], v1 offset:3072
s_waitcnt lgkmcnt(3)
v_mfma_f32_16x16x32_bf16 v[48:51], v[64:67], v[40:43], v[48:51]
s_add_u32 s9, s19, 32768
buffer_load_dwordx4 v[192:195], v1, s[52:55], s9 offen offset:0 sc1
ds_read_b128 v[40:43], v1 offset:4096
s_waitcnt lgkmcnt(3)
v_mfma_f32_16x16x32_bf16 v[48:51], v[68:71], v[44:47], v[48:51]
s_add_u32 s9, s19, 32768
buffer_load_dwordx4 v[196:199], v1, s[52:55], s9 offen offset:1024 sc1
ds_read_b128 v[44:47], v1 offset:5120
s_waitcnt lgkmcnt(3)
v_mfma_f32_16x16x32_bf16 v[48:51], v[72:75], v[32:35], v[48:51]
s_add_u32 s9, s19, 32768
buffer_load_dwordx4 v[200:203], v1, s[52:55], s9 offen offset:2048 sc1
ds_read_b128 v[32:35], v1 offset:6144
s_waitcnt lgkmcnt(3)
v_mfma_f32_16x16x32_bf16 v[48:51], v[76:79], v[36:39], v[48:51]
s_add_u32 s9, s19, 32768
buffer_load_dwordx4 v[204:207], v1, s[52:55], s9 offen offset:3072 sc1
ds_read_b128 v[36:39], v1 offset:7168
s_waitcnt lgkmcnt(3)
v_mfma_f32_16x16x32_bf16 v[48:51], v[80:83], v[40:43], v[48:51]
s_add_u32 s9, s19, 45056
buffer_load_dwordx4 v[240:243], v1, s[52:55], s9 offen offset:0 sc1
ds_read_b128 v[40:43], v1 offset:8192
s_waitcnt lgkmcnt(3)
v_mfma_f32_16x16x32_bf16 v[48:51], v[84:87], v[44:47], v[48:51]
s_add_u32 s9, s19, 45056
buffer_load_dwordx4 v[244:247], v1, s[52:55], s9 offen offset:1024 sc1
ds_read_b128 v[44:47], v1 offset:9216
s_waitcnt lgkmcnt(3)
v_mfma_f32_16x16x32_bf16 v[48:51], v[88:91], v[32:35], v[48:51]
s_add_u32 s9, s19, 45056
buffer_load_dwordx4 v[248:251], v1, s[52:55], s9 offen offset:2048 sc1
ds_read_b128 v[32:35], v1 offset:10240
s_waitcnt lgkmcnt(3)
v_mfma_f32_16x16x32_bf16 v[48:51], v[92:95], v[36:39], v[48:51]
s_add_u32 s9, s19, 45056
buffer_load_dwordx4 v[252:255], v1, s[52:55], s9 offen offset:3072 sc1
ds_read_b128 v[36:39], v1 offset:11264
s_waitcnt lgkmcnt(3)
v_mfma_f32_16x16x32_bf16 v[48:51], v[96:99], v[40:43], v[48:51]
s_add_u32 s9, s19, 49152
buffer_load_dwordx4 v[56:59], v1, s[52:55], s9 offen offset:0 sc1
ds_read_b128 v[40:43], v1 offset:12288
s_waitcnt lgkmcnt(3)
v_mfma_f32_16x16x32_bf16 v[48:51], v[100:103], v[44:47], v[48:51]
s_add_u32 s9, s19, 49152
buffer_load_dwordx4 v[60:63], v1, s[52:55], s9 offen offset:1024 sc1
ds_read_b128 v[44:47], v1 offset:13312
s_waitcnt lgkmcnt(3)
v_mfma_f32_16x16x32_bf16 v[48:51], v[104:107], v[32:35], v[48:51]
ds_read_b128 v[32:35], v1 offset:14336
s_waitcnt lgkmcnt(3)
v_mfma_f32_16x16x32_bf16 v[48:51], v[108:111], v[36:39], v[48:51]
ds_read_b128 v[36:39], v1 offset:15360
s_waitcnt lgkmcnt(3)
v_mfma_f32_16x16x32_bf16 v[48:51], v[112:115], v[40:43], v[48:51]
ds_read_b128 v[40:43], v1 offset:16384
s_waitcnt lgkmcnt(3)
v_mfma_f32_16x16x32_bf16 v[48:51], v[116:119], v[44:47], v[48:51]
ds_read_b128 v[44:47], v1 offset:17408
s_waitcnt lgkmcnt(3)
v_mfma_f32_16x16x32_bf16 v[48:51], v[120:123], v[32:35], v[48:51]
ds_read_b128 v[32:35], v1 offset:18432
s_waitcnt lgkmcnt(3)
v_mfma_f32_16x16x32_bf16 v[48:51], v[124:127], v[36:39], v[48:51]
ds_read_b128 v[36:39], v1 offset:19456
s_waitcnt lgkmcnt(3)
v_mfma_f32_16x16x32_bf16 v[48:51], v[128:131], v[40:43], v[48:51]
ds_read_b128 v[40:43], v1 offset:20480
s_waitcnt lgkmcnt(3)
v_mfma_f32_16x16x32_bf16 v[48:51], v[132:135], v[44:47], v[48:51]
ds_read_b128 v[44:47], v1 offset:21504
s_waitcnt lgkmcnt(3)
v_mfma_f32_16x16x32_bf16 v[48:51], v[136:139], v[32:35], v[48:51]
ds_read_b128 v[32:35], v1 offset:22528
s_waitcnt lgkmcnt(3)
v_mfma_f32_16x16x32_bf16 v[48:51], v[140:143], v[36:39], v[48:51]
ds_read_b128 v[36:39], v1 offset:23552
s_waitcnt lgkmcnt(3)
v_mfma_f32_16x16x32_bf16 v[48:51], v[144:147], v[40:43], v[48:51]
ds_read_b128 v[40:43], v1 offset:24576
s_waitcnt lgkmcnt(3)
v_mfma_f32_16x16x32_bf16 v[48:51], v[148:151], v[44:47], v[48:51]
ds_read_b128 v[44:47], v1 offset:25600
s_waitcnt vmcnt(19)
s_waitcnt lgkmcnt(3)
v_mfma_f32_16x16x32_bf16 v[48:51], v[152:155], v[32:35], v[48:51]
ds_read_b128 v[32:35], v1 offset:36864
s_waitcnt vmcnt(18)
s_waitcnt lgkmcnt(3)
v_mfma_f32_16x16x32_bf16 v[48:51], v[156:159], v[36:39], v[48:51]
ds_read_b128 v[36:39], v1 offset:37888
s_waitcnt vmcnt(17)
s_waitcnt lgkmcnt(3)
v_mfma_f32_16x16x32_bf16 v[48:51], v[160:163], v[40:43], v[48:51]
ds_read_b128 v[40:43], v1 offset:38912
s_waitcnt vmcnt(16)
s_waitcnt lgkmcnt(3)
v_mfma_f32_16x16x32_bf16 v[48:51], v[164:167], v[44:47], v[48:51]
ds_read_b128 v[44:47], v1 offset:39936
s_waitcnt lgkmcnt(3)
v_mfma_f32_16x16x32_bf16 v[48:51], v[208:211], v[32:35], v[48:51]
ds_read_b128 v[32:35], v1 offset:40960
s_waitcnt lgkmcnt(3)
v_mfma_f32_16x16x32_bf16 v[48:51], v[212:215], v[36:39], v[48:51]
ds_read_b128 v[36:39], v1 offset:41984
s_waitcnt lgkmcnt(3)
v_mfma_f32_16x16x32_bf16 v[48:51], v[216:219], v[40:43], v[48:51]
ds_read_b128 v[40:43], v1 offset:43008
s_waitcnt lgkmcnt(3)
v_mfma_f32_16x16x32_bf16 v[48:51], v[220:223], v[44:47], v[48:51]
ds_read_b128 v[44:47], v1 offset:44032
s_waitcnt lgkmcnt(3)
v_mfma_f32_16x16x32_bf16 v[48:51], v[224:227], v[32:35], v[48:51]
ds_read_b128 v[32:35], v1 offset:26624
s_waitcnt lgkmcnt(3)
v_mfma_f32_16x16x32_bf16 v[48:51], v[228:231], v[36:39], v[48:51]
ds_read_b128 v[36:39], v1 offset:27648
s_waitcnt lgkmcnt(3)
v_mfma_f32_16x16x32_bf16 v[48:51], v[232:235], v[40:43], v[48:51]
ds_read_b128 v[40:43], v1 offset:28672
s_waitcnt lgkmcnt(3)
v_mfma_f32_16x16x32_bf16 v[48:51], v[236:239], v[44:47], v[48:51]
ds_read_b128 v[44:47], v1 offset:29696
s_waitcnt vmcnt(15)
s_waitcnt lgkmcnt(3)
v_mfma_f32_16x16x32_bf16 v[48:51], v[168:171], v[32:35], v[48:51]
ds_read_b128 v[32:35], v1 offset:30720
s_waitcnt vmcnt(14)
s_waitcnt lgkmcnt(3)
v_mfma_f32_16x16x32_bf16 v[48:51], v[172:175], v[36:39], v[48:51]
ds_read_b128 v[36:39], v1 offset:31744
s_waitcnt vmcnt(13)
s_waitcnt lgkmcnt(3)
v_mfma_f32_16x16x32_bf16 v[48:51], v[176:179], v[40:43], v[48:51]
ds_read_b128 v[40:43], v1 offset:32768
s_waitcnt vmcnt(12)
s_waitcnt lgkmcnt(3)
v_mfma_f32_16x16x32_bf16 v[48:51], v[180:183], v[44:47], v[48:51]
ds_read_b128 v[44:47], v1 offset:33792
s_waitcnt vmcnt(11)
s_waitcnt lgkmcnt(3)
v_mfma_f32_16x16x32_bf16 v[48:51], v[184:187], v[32:35], v[48:51]
ds_read_b128 v[32:35], v1 offset:34816
s_waitcnt vmcnt(10)
s_waitcnt lgkmcnt(3)
v_mfma_f32_16x16x32_bf16 v[48:51], v[188:191], v[36:39], v[48:51]
ds_read_b128 v[36:39], v1 offset:35840
s_waitcnt vmcnt(9)
s_waitcnt lgkmcnt(3)
v_mfma_f32_16x16x32_bf16 v[48:51], v[192:195], v[40:43], v[48:51]
ds_read_b128 v[40:43], v1 offset:45056
s_waitcnt vmcnt(8)
s_waitcnt lgkmcnt(3)
v_mfma_f32_16x16x32_bf16 v[48:51], v[196:199], v[44:47], v[48:51]
ds_read_b128 v[44:47], v1 offset:46080
s_waitcnt vmcnt(7)
s_waitcnt lgkmcnt(3)
v_mfma_f32_16x16x32_bf16 v[48:51], v[200:203], v[32:35], v[48:51]
ds_read_b128 v[32:35], v1 offset:47104
s_waitcnt vmcnt(6)
s_waitcnt lgkmcnt(3)
v_mfma_f32_16x16x32_bf16 v[48:51], v[204:207], v[36:39], v[48:51]
ds_read_b128 v[36:39], v1 offset:48128
s_waitcnt vmcnt(5)
s_waitcnt lgkmcnt(3)
v_mfma_f32_16x16x32_bf16 v[48:51], v[240:243], v[40:43], v[48:51]
ds_read_b128 v[40:43], v1 offset:49152
s_waitcnt vmcnt(4)
s_waitcnt lgkmcnt(3)
v_mfma_f32_16x16x32_bf16 v[48:51], v[244:247], v[44:47], v[48:51]
ds_read_b128 v[44:47], v1 offset:50176
s_waitcnt vmcnt(3)
s_waitcnt lgkmcnt(3)
v_mfma_f32_16x16x32_bf16 v[48:51], v[248:251], v[32:35], v[48:51]
s_waitcnt vmcnt(2)
s_waitcnt lgkmcnt(2)
v_mfma_f32_16x16x32_bf16 v[48:51], v[252:255], v[36:39], v[48:51]
s_waitcnt vmcnt(1)
s_waitcnt lgkmcnt(1)
v_mfma_f32_16x16x32_bf16 v[48:51], v[56:59], v[40:43], v[48:51]
s_waitcnt vmcnt(0)
s_waitcnt lgkmcnt(0)
v_mfma_f32_16x16x32_bf16 v[48:51], v[60:63], v[44:47], v[48:51]
ds_read_b128 v[16:19], v9 offset:0
ds_read_b128 v[28:31], v9 offset:1024
ds_read_b128 v[4:7], v9 offset:2048
s_barrier
ds_read_b128 v[32:35], v2 offset:51200
ds_read_b128 v[36:39], v2 offset:52224
ds_read_b128 v[40:43], v2 offset:53248
ds_read_b128 v[44:47], v2 offset:54272
s_waitcnt lgkmcnt(6)
s_waitcnt lgkmcnt(3)
v_mfma_f32_16x16x32_bf16 v[52:55], v[16:19], v[32:35], 0
ds_read_b128 v[16:19], v9 offset:3072
ds_read_b128 v[32:35], v2 offset:55296
s_waitcnt lgkmcnt(4)
v_mfma_f32_16x16x32_bf16 v[52:55], v[28:31], v[36:39], v[52:55]
ds_read_b128 v[28:31], v9 offset:4096
ds_read_b128 v[36:39], v2 offset:56320
s_waitcnt lgkmcnt(5)
v_mfma_f32_16x16x32_bf16 v[52:55], v[4:7], v[40:43], v[52:55]
ds_read_b128 v[4:7], v9 offset:5120
ds_read_b128 v[40:43], v2 offset:0
s_waitcnt lgkmcnt(5)
v_mfma_f32_16x16x32_bf16 v[52:55], v[16:19], v[44:47], v[52:55]
ds_read_b128 v[44:47], v2 offset:1024
s_waitcnt lgkmcnt(4)
v_mfma_f32_16x16x32_bf16 v[52:55], v[28:31], v[32:35], v[52:55]
ds_read_b128 v[32:35], v2 offset:2048
s_waitcnt lgkmcnt(3)
v_mfma_f32_16x16x32_bf16 v[52:55], v[4:7], v[36:39], v[52:55]
ds_read_b128 v[36:39], v2 offset:3072
s_waitcnt lgkmcnt(3)
v_mfma_f32_16x16x32_bf16 v[52:55], v[64:67], v[40:43], v[52:55]
ds_read_b128 v[40:43], v2 offset:4096
s_waitcnt lgkmcnt(3)
v_mfma_f32_16x16x32_bf16 v[52:55], v[68:71], v[44:47], v[52:55]
ds_read_b128 v[44:47], v2 offset:5120
s_waitcnt lgkmcnt(3)
v_mfma_f32_16x16x32_bf16 v[52:55], v[72:75], v[32:35], v[52:55]
ds_read_b128 v[32:35], v2 offset:6144
s_waitcnt lgkmcnt(3)
v_mfma_f32_16x16x32_bf16 v[52:55], v[76:79], v[36:39], v[52:55]
ds_read_b128 v[36:39], v2 offset:7168
s_waitcnt lgkmcnt(3)
v_mfma_f32_16x16x32_bf16 v[52:55], v[80:83], v[40:43], v[52:55]
s_barrier
ds_read_b128 v[40:43], v2 offset:8192
s_waitcnt lgkmcnt(3)
v_mfma_f32_16x16x32_bf16 v[52:55], v[84:87], v[44:47], v[52:55]
ds_read_b128 v[44:47], v2 offset:9216
s_waitcnt lgkmcnt(3)
v_mfma_f32_16x16x32_bf16 v[52:55], v[88:91], v[32:35], v[52:55]
ds_read_b128 v[32:35], v2 offset:10240
s_waitcnt lgkmcnt(3)
v_mfma_f32_16x16x32_bf16 v[52:55], v[92:95], v[36:39], v[52:55]
ds_read_b128 v[36:39], v2 offset:11264
s_waitcnt lgkmcnt(3)
v_mfma_f32_16x16x32_bf16 v[52:55], v[96:99], v[40:43], v[52:55]
ds_read_b128 v[40:43], v2 offset:12288
s_waitcnt lgkmcnt(3)
v_mfma_f32_16x16x32_bf16 v[52:55], v[100:103], v[44:47], v[52:55]
ds_read_b128 v[44:47], v2 offset:13312
s_waitcnt lgkmcnt(3)
v_mfma_f32_16x16x32_bf16 v[52:55], v[104:107], v[32:35], v[52:55]
ds_read_b128 v[32:35], v2 offset:14336
s_waitcnt lgkmcnt(3)
v_mfma_f32_16x16x32_bf16 v[52:55], v[108:111], v[36:39], v[52:55]
ds_read_b128 v[36:39], v2 offset:15360
s_waitcnt lgkmcnt(3)
v_mfma_f32_16x16x32_bf16 v[52:55], v[112:115], v[40:43], v[52:55]
ds_read_b128 v[40:43], v2 offset:16384
s_waitcnt lgkmcnt(3)
v_mfma_f32_16x16x32_bf16 v[52:55], v[116:119], v[44:47], v[52:55]
ds_read_b128 v[44:47], v2 offset:17408
s_waitcnt lgkmcnt(3)
v_mfma_f32_16x16x32_bf16 v[52:55], v[120:123], v[32:35], v[52:55]
ds_read_b128 v[32:35], v2 offset:18432
s_waitcnt lgkmcnt(3)
v_mfma_f32_16x16x32_bf16 v[52:55], v[124:127], v[36:39], v[52:55]
ds_read_b128 v[36:39], v2 offset:19456
s_waitcnt lgkmcnt(3)
v_mfma_f32_16x16x32_bf16 v[52:55], v[128:131], v[40:43], v[52:55]
ds_read_b128 v[40:43], v2 offset:20480
s_waitcnt lgkmcnt(3)
v_mfma_f32_16x16x32_bf16 v[52:55], v[132:135], v[44:47], v[52:55]
ds_read_b128 v[44:47], v2 offset:21504
s_waitcnt lgkmcnt(3)
v_mfma_f32_16x16x32_bf16 v[52:55], v[136:139], v[32:35], v[52:55]
s_barrier
ds_read_b128 v[32:35], v2 offset:22528
s_waitcnt lgkmcnt(3)
v_mfma_f32_16x16x32_bf16 v[52:55], v[140:143], v[36:39], v[52:55]
ds_read_b128 v[36:39], v2 offset:23552
s_waitcnt lgkmcnt(3)
v_mfma_f32_16x16x32_bf16 v[52:55], v[144:147], v[40:43], v[52:55]
ds_read_b128 v[40:43], v2 offset:24576
s_waitcnt lgkmcnt(3)
v_mfma_f32_16x16x32_bf16 v[52:55], v[148:151], v[44:47], v[52:55]
ds_read_b128 v[44:47], v2 offset:25600
s_waitcnt lgkmcnt(3)
v_mfma_f32_16x16x32_bf16 v[52:55], v[152:155], v[32:35], v[52:55]
ds_read_b128 v[32:35], v2 offset:36864
s_waitcnt lgkmcnt(3)
v_mfma_f32_16x16x32_bf16 v[52:55], v[156:159], v[36:39], v[52:55]
ds_read_b128 v[36:39], v2 offset:37888
s_waitcnt lgkmcnt(3)
v_mfma_f32_16x16x32_bf16 v[52:55], v[160:163], v[40:43], v[52:55]
ds_read_b128 v[40:43], v2 offset:38912
s_waitcnt lgkmcnt(3)
v_mfma_f32_16x16x32_bf16 v[52:55], v[164:167], v[44:47], v[52:55]
ds_read_b128 v[44:47], v2 offset:39936
s_waitcnt lgkmcnt(3)
v_mfma_f32_16x16x32_bf16 v[52:55], v[208:211], v[32:35], v[52:55]
ds_read_b128 v[32:35], v2 offset:40960
s_waitcnt lgkmcnt(3)
v_mfma_f32_16x16x32_bf16 v[52:55], v[212:215], v[36:39], v[52:55]
ds_read_b128 v[36:39], v2 offset:41984
s_waitcnt lgkmcnt(3)
v_mfma_f32_16x16x32_bf16 v[52:55], v[216:219], v[40:43], v[52:55]
ds_read_b128 v[40:43], v2 offset:43008
s_waitcnt lgkmcnt(3)
v_mfma_f32_16x16x32_bf16 v[52:55], v[220:223], v[44:47], v[52:55]
ds_read_b128 v[44:47], v2 offset:44032
s_waitcnt lgkmcnt(3)
v_mfma_f32_16x16x32_bf16 v[52:55], v[224:227], v[32:35], v[52:55]
ds_read_b128 v[32:35], v2 offset:26624
s_waitcnt lgkmcnt(3)
v_mfma_f32_16x16x32_bf16 v[52:55], v[228:231], v[36:39], v[52:55]
ds_read_b128 v[36:39], v2 offset:27648
s_waitcnt lgkmcnt(3)
v_mfma_f32_16x16x32_bf16 v[52:55], v[232:235], v[40:43], v[52:55]
s_barrier
ds_read_b128 v[40:43], v2 offset:28672
s_waitcnt lgkmcnt(3)
v_mfma_f32_16x16x32_bf16 v[52:55], v[236:239], v[44:47], v[52:55]
ds_read_b128 v[44:47], v2 offset:29696
s_waitcnt lgkmcnt(3)
v_mfma_f32_16x16x32_bf16 v[52:55], v[168:171], v[32:35], v[52:55]
ds_read_b128 v[32:35], v2 offset:30720
s_waitcnt lgkmcnt(3)
v_mfma_f32_16x16x32_bf16 v[52:55], v[172:175], v[36:39], v[52:55]
ds_read_b128 v[36:39], v2 offset:31744
s_waitcnt lgkmcnt(3)
v_mfma_f32_16x16x32_bf16 v[52:55], v[176:179], v[40:43], v[52:55]
ds_read_b128 v[40:43], v2 offset:32768
s_waitcnt lgkmcnt(3)
v_mfma_f32_16x16x32_bf16 v[52:55], v[180:183], v[44:47], v[52:55]
ds_read_b128 v[44:47], v2 offset:33792
s_waitcnt lgkmcnt(3)
v_mfma_f32_16x16x32_bf16 v[52:55], v[184:187], v[32:35], v[52:55]
ds_read_b128 v[32:35], v2 offset:34816
s_waitcnt lgkmcnt(3)
v_mfma_f32_16x16x32_bf16 v[52:55], v[188:191], v[36:39], v[52:55]
ds_read_b128 v[36:39], v2 offset:35840
s_waitcnt lgkmcnt(3)
v_mfma_f32_16x16x32_bf16 v[52:55], v[192:195], v[40:43], v[52:55]
ds_read_b128 v[40:43], v2 offset:45056
s_waitcnt lgkmcnt(3)
v_mfma_f32_16x16x32_bf16 v[52:55], v[196:199], v[44:47], v[52:55]
ds_read_b128 v[44:47], v2 offset:46080
s_waitcnt lgkmcnt(3)
v_mfma_f32_16x16x32_bf16 v[52:55], v[200:203], v[32:35], v[52:55]
ds_read_b128 v[32:35], v2 offset:47104
s_waitcnt lgkmcnt(3)
v_mfma_f32_16x16x32_bf16 v[52:55], v[204:207], v[36:39], v[52:55]
ds_read_b128 v[36:39], v2 offset:48128
s_waitcnt lgkmcnt(3)
v_mfma_f32_16x16x32_bf16 v[52:55], v[240:243], v[40:43], v[52:55]
ds_read_b128 v[40:43], v2 offset:49152
s_waitcnt lgkmcnt(3)
v_mfma_f32_16x16x32_bf16 v[52:55], v[244:247], v[44:47], v[52:55]
ds_read_b128 v[44:47], v2 offset:50176
s_waitcnt lgkmcnt(3)
v_mfma_f32_16x16x32_bf16 v[52:55], v[248:251], v[32:35], v[52:55]
s_waitcnt lgkmcnt(2)
v_mfma_f32_16x16x32_bf16 v[52:55], v[252:255], v[36:39], v[52:55]
s_waitcnt lgkmcnt(1)
v_mfma_f32_16x16x32_bf16 v[52:55], v[56:59], v[40:43], v[52:55]
s_waitcnt lgkmcnt(0)
v_mfma_f32_16x16x32_bf16 v[52:55], v[60:63], v[44:47], v[52:55]
v_lshlrev_b32 v32, 16, v20
v_and_b32 v33, 0xffff0000, v20
v_lshlrev_b32 v34, 16, v21
v_and_b32 v35, 0xffff0000, v21
v_lshlrev_b32 v36, 16, v22
v_and_b32 v37, 0xffff0000, v22
v_lshlrev_b32 v38, 16, v23
v_and_b32 v39, 0xffff0000, v23
s_mul_i32 s4, s23, 14336
s_lshl_b32 s5, s22, 5
s_add_u32 s4, s4, s5
v_add_f32 v32, v32, v48
v_add_f32 v33, v33, v49
v_add_f32 v34, v34, v50
v_add_f32 v35, v35, v51
v_add_f32 v36, v36, v52
v_add_f32 v37, v37, v53
v_add_f32 v38, v38, v54
v_add_f32 v39, v39, v55
v_cvt_pk_bf16_f32 v40, v32, v33
v_cvt_pk_bf16_f32 v41, v34, v35
v_cvt_pk_bf16_f32 v42, v36, v37
v_cvt_pk_bf16_f32 v43, v38, v39
s_nop 0
v_permlane16_swap_b32 v40, v42
v_permlane16_swap_b32 v41, v43
buffer_store_dwordx4 v[40:43], v10, s[44:47], s4 offen
s_branch L_end
L_w7path:
s_setprio 3
s_mov_b32 exec_lo, 0xffff
s_mov_b32 exec_hi, 0x0
s_mov_b32 s4, 0x8000
s_mov_b32 s10, 0
L72:
buffer_load_dwordx2 v[26:27], v13, s[52:55], s4 offen sc1
s_add_u32 s10, s10, 1
s_cmp_lg_u32 s10, 0x1000
s_cbranch_scc1 L74
v_and_b32 v13, 0x7ffff, v13
L74:
s_cmp_gt_u32 s10, 0x40000
s_waitcnt vmcnt(0)
s_cbranch_scc1 L73
v_cmp_ne_u64 vcc, v[26:27], v[24:25]
s_cbranch_vccnz L72
L73:
s_mov_b64 exec, -1
s_lshr_b32 s6, s64, 2
s_lshl_b32 s6, s6, 2
s_add_u32 s4, s23, s6
s_lshl_b32 s4, s4, 14
s_and_b32 s6, s64, 3
s_lshl_b32 s6, s6, 12
s_add_u32 s7, s4, s6
s_add_u32 s7, s7, 0xc00000
s_lshl_b32 s5, s64, 12
s_add_u32 m0, s5, 114688
s_barrier
buffer_load_dwordx4 v1, s[52:55], s7 offen offset:0 sc1 lds
buffer_load_dwordx4 v1, s[52:55], s7 offen offset:1024 sc1 lds
buffer_load_dwordx4 v1, s[52:55], s7 offen offset:2048 sc1 lds
buffer_load_dwordx4 v1, s[52:55], s7 offen offset:3072 sc1 lds
s_cmp_lg_u32 s68, 0
s_cbranch_scc1 L75
s_mov_b32 s4, 0x22000
buffer_load_dwordx4 v[40:43], v1, s[52:55], s4 offen sc1
buffer_load_dwordx4 v[44:47], v1, s[52:55], s4 offen offset:1024 sc1
s_waitcnt vmcnt(0)
v_cmp_ne_u64 s[12:13], v[40:41], v[24:25]
v_cmp_ne_u64 s[76:77], v[42:43], v[24:25]
v_cmp_ne_u64 s[78:79], v[44:45], v[24:25]
v_cmp_ne_u64 s[80:81], v[46:47], v[24:25]
s_or_b64 s[12:13], s[12:13], s[76:77]
s_or_b64 s[78:79], s[78:79], s[80:81]
s_or_b64 s[12:13], s[12:13], s[78:79]
s_cselect_b32 s68, 0, 1
v_mov_b32 v40, s68
ds_write_b32 v11, v40 offset:20
s_waitcnt lgkmcnt(0)
L75:
s_waitcnt vmcnt(0)
s_barrier
s_cmp_lg_u32 s68, 0
s_cbranch_scc1 L77
s_mov_b32 s10, 0
L76:
s_add_u32 s10, s10, 1
s_cmp_gt_u32 s10, 0x40000
s_cbranch_scc1 L77
s_mov_b32 s4, 0x22000
buffer_load_dwordx4 v[40:43], v1, s[52:55], s4 offen sc1
buffer_load_dwordx4 v[44:47], v1, s[52:55], s4 offen offset:1024 sc1
s_waitcnt vmcnt(0)
v_cmp_ne_u64 s[12:13], v[40:41], v[24:25]
v_cmp_ne_u64 s[76:77], v[42:43], v[24:25]
v_cmp_ne_u64 s[78:79], v[44:45], v[24:25]
v_cmp_ne_u64 s[80:81], v[46:47], v[24:25]
s_or_b64 s[12:13], s[12:13], s[76:77]
s_or_b64 s[78:79], s[78:79], s[80:81]
s_or_b64 s[12:13], s[12:13], s[78:79]
s_cbranch_scc1 L76
L77:
s_mov_b32 s76, 0x22222222
s_mov_b32 s77, 0x22222222
s_mov_b32 s78, 0x44444444
s_mov_b32 s79, 0x44444444
s_mov_b32 s80, 0x88888888
s_mov_b32 s81, 0x88888888
v_lshlrev_b32 v9, 4, v15
v_add_u32 v9, 157696, v9
s_barrier
s_mov_b32 exec_lo, 0x0
s_mov_b32 exec_hi, 0xffff
s_mov_b32 s4, 0x10000
s_mov_b32 s10, 0
L78:
buffer_load_dwordx2 v[26:27], v13, s[52:55], s4 offen sc1
s_add_u32 s10, s10, 1
s_cmp_lg_u32 s10, 0x1000
s_cbranch_scc1 L80
v_and_b32 v13, 0x7ffff, v13
L80:
s_cmp_gt_u32 s10, 0x40000
s_waitcnt vmcnt(0)
s_cbranch_scc1 L79
v_cmp_ne_u64 vcc, v[26:27], v[24:25]
s_cbranch_vccnz L78
L79:
s_mov_b64 exec, -1
s_and_b32 s6, s64, 3
s_mul_i32 s27, s6, 14336
s_lshr_b32 s8, s64, 2
s_lshl_b32 s6, s8, 10
s_add_u32 s27, s27, s6
s_mul_i32 s26, s101, 114688
s_add_u32 s26, s26, s27
s_add_u32 s26, s26, 0xe00000
s_barrier
s_add_u32 m0, s27, 0
s_add_u32 s6, s26, 0
buffer_load_dwordx4 v1, s[52:55], s6 offen sc1 lds
s_add_u32 m0, s27, 2048
s_add_u32 s6, s26, 2048
buffer_load_dwordx4 v1, s[52:55], s6 offen sc1 lds
s_add_u32 m0, s27, 4096
s_add_u32 s6, s26, 4096
buffer_load_dwordx4 v1, s[52:55], s6 offen sc1 lds
s_add_u32 m0, s27, 6144
s_add_u32 s6, s26, 6144
buffer_load_dwordx4 v1, s[52:55], s6 offen sc1 lds
s_add_u32 m0, s27, 8192
s_add_u32 s6, s26, 8192
buffer_load_dwordx4 v1, s[52:55], s6 offen sc1 lds
s_add_u32 m0, s27, 10240
s_add_u32 s6, s26, 10240
buffer_load_dwordx4 v1, s[52:55], s6 offen sc1 lds
s_add_u32 m0, s27, 12288
s_add_u32 s6, s26, 12288
buffer_load_dwordx4 v1, s[52:55], s6 offen sc1 lds
s_waitcnt vmcnt(6)
s_barrier
ds_read_b128 v[160:163], v1 offset:0
ds_read_b128 v[164:167], v1 offset:14336
ds_read_b128 v[168:171], v1 offset:28672
ds_read_b128 v[172:175], v1 offset:43008
ds_read_b128 v[176:179], v1 offset:1024
ds_read_b128 v[180:183], v1 offset:15360
ds_read_b128 v[184:187], v1 offset:29696
ds_read_b128 v[188:191], v1 offset:44032
s_waitcnt lgkmcnt(7)
v_mfma_f32_16x16x32_bf16 v[64:67], v[160:163], v[160:163], 0
v_mfma_f32_16x16x32_bf16 v[96:99], v[16:19], v[160:163], 0
s_waitcnt vmcnt(4)
s_barrier
ds_read_b128 v[192:195], v1 offset:2048
ds_read_b128 v[196:199], v1 offset:16384
ds_read_b128 v[200:203], v1 offset:30720
ds_read_b128 v[204:207], v1 offset:45056
s_waitcnt lgkmcnt(10)
v_mfma_f32_16x16x32_bf16 v[68:71], v[164:167], v[164:167], 0
v_mfma_f32_16x16x32_bf16 v[100:103], v[16:19], v[164:167], 0
s_waitcnt lgkmcnt(9)
v_mfma_f32_16x16x32_bf16 v[72:75], v[168:171], v[168:171], 0
v_mfma_f32_16x16x32_bf16 v[104:107], v[16:19], v[168:171], 0
s_waitcnt lgkmcnt(8)
v_mfma_f32_16x16x32_bf16 v[76:79], v[172:175], v[172:175], 0
v_mfma_f32_16x16x32_bf16 v[108:111], v[16:19], v[172:175], 0
s_add_u32 m0, s27, 57344
s_add_u32 s6, s26, 57344
buffer_load_dwordx4 v1, s[52:55], s6 offen sc1 lds
s_waitcnt lgkmcnt(7)
v_mfma_f32_16x16x32_bf16 v[64:67], v[176:179], v[176:179], v[64:67]
v_mfma_f32_16x16x32_bf16 v[96:99], v[16:19], v[176:179], v[96:99]
ds_read_b128 v[160:163], v1 offset:3072
ds_read_b128 v[164:167], v1 offset:17408
ds_read_b128 v[168:171], v1 offset:31744
ds_read_b128 v[172:175], v1 offset:46080
s_waitcnt lgkmcnt(10)
v_mfma_f32_16x16x32_bf16 v[68:71], v[180:183], v[180:183], v[68:71]
v_mfma_f32_16x16x32_bf16 v[100:103], v[16:19], v[180:183], v[100:103]
s_waitcnt lgkmcnt(9)
v_mfma_f32_16x16x32_bf16 v[72:75], v[184:187], v[184:187], v[72:75]
v_mfma_f32_16x16x32_bf16 v[104:107], v[16:19], v[184:187], v[104:107]
s_waitcnt lgkmcnt(8)
v_mfma_f32_16x16x32_bf16 v[76:79], v[188:191], v[188:191], v[76:79]
v_mfma_f32_16x16x32_bf16 v[108:111], v[16:19], v[188:191], v[108:111]
s_add_u32 m0, s27, 59392
s_add_u32 s6, s26, 59392
buffer_load_dwordx4 v1, s[52:55], s6 offen sc1 lds
s_waitcnt lgkmcnt(7)
v_mfma_f32_16x16x32_bf16 v[64:67], v[192:195], v[192:195], v[64:67]
v_mfma_f32_16x16x32_bf16 v[96:99], v[16:19], v[192:195], v[96:99]
ds_read_b128 v[176:179], v1 offset:4096
ds_read_b128 v[180:183], v1 offset:18432
ds_read_b128 v[184:187], v1 offset:32768
ds_read_b128 v[188:191], v1 offset:47104
s_waitcnt lgkmcnt(10)
v_mfma_f32_16x16x32_bf16 v[68:71], v[196:199], v[196:199], v[68:71]
v_mfma_f32_16x16x32_bf16 v[100:103], v[16:19], v[196:199], v[100:103]
s_waitcnt lgkmcnt(9)
v_mfma_f32_16x16x32_bf16 v[72:75], v[200:203], v[200:203], v[72:75]
v_mfma_f32_16x16x32_bf16 v[104:107], v[16:19], v[200:203], v[104:107]
s_waitcnt lgkmcnt(8)
v_mfma_f32_16x16x32_bf16 v[76:79], v[204:207], v[204:207], v[76:79]
v_mfma_f32_16x16x32_bf16 v[108:111], v[16:19], v[204:207], v[108:111]
s_add_u32 m0, s27, 61440
s_add_u32 s6, s26, 61440
buffer_load_dwordx4 v1, s[52:55], s6 offen sc1 lds
s_waitcnt lgkmcnt(7)
v_mfma_f32_16x16x32_bf16 v[64:67], v[160:163], v[160:163], v[64:67]
v_mfma_f32_16x16x32_bf16 v[96:99], v[16:19], v[160:163], v[96:99]
ds_read_b128 v[192:195], v1 offset:5120
ds_read_b128 v[196:199], v1 offset:19456
ds_read_b128 v[200:203], v1 offset:33792
ds_read_b128 v[204:207], v1 offset:48128
s_waitcnt lgkmcnt(10)
v_mfma_f32_16x16x32_bf16 v[68:71], v[164:167], v[164:167], v[68:71]
v_mfma_f32_16x16x32_bf16 v[100:103], v[16:19], v[164:167], v[100:103]
s_waitcnt lgkmcnt(9)
v_mfma_f32_16x16x32_bf16 v[72:75], v[168:171], v[168:171], v[72:75]
v_mfma_f32_16x16x32_bf16 v[104:107], v[16:19], v[168:171], v[104:107]
s_waitcnt lgkmcnt(8)
v_mfma_f32_16x16x32_bf16 v[76:79], v[172:175], v[172:175], v[76:79]
v_mfma_f32_16x16x32_bf16 v[108:111], v[16:19], v[172:175], v[108:111]
s_add_u32 m0, s27, 63488
s_add_u32 s6, s26, 63488
buffer_load_dwordx4 v1, s[52:55], s6 offen sc1 lds
s_waitcnt lgkmcnt(7)
v_mfma_f32_16x16x32_bf16 v[64:67], v[176:179], v[176:179], v[64:67]
v_mfma_f32_16x16x32_bf16 v[96:99], v[16:19], v[176:179], v[96:99]
s_waitcnt vmcnt(4)
s_barrier
ds_read_b128 v[160:163], v1 offset:6144
ds_read_b128 v[164:167], v1 offset:20480
ds_read_b128 v[168:171], v1 offset:34816
ds_read_b128 v[172:175], v1 offset:49152
s_waitcnt lgkmcnt(10)
v_mfma_f32_16x16x32_bf16 v[68:71], v[180:183], v[180:183], v[68:71]
v_mfma_f32_16x16x32_bf16 v[100:103], v[16:19], v[180:183], v[100:103]
s_waitcnt lgkmcnt(9)
v_mfma_f32_16x16x32_bf16 v[72:75], v[184:187], v[184:187], v[72:75]
v_mfma_f32_16x16x32_bf16 v[104:107], v[16:19], v[184:187], v[104:107]
s_waitcnt lgkmcnt(8)
v_mfma_f32_16x16x32_bf16 v[76:79], v[188:191], v[188:191], v[76:79]
v_mfma_f32_16x16x32_bf16 v[108:111], v[16:19], v[188:191], v[108:111]
s_add_u32 m0, s27, 65536
s_add_u32 s6, s26, 65536
buffer_load_dwordx4 v1, s[52:55], s6 offen sc1 lds
s_waitcnt lgkmcnt(7)
v_mfma_f32_16x16x32_bf16 v[64:67], v[192:195], v[192:195], v[64:67]
v_mfma_f32_16x16x32_bf16 v[96:99], v[16:19], v[192:195], v[96:99]
ds_read_b128 v[176:179], v1 offset:7168
ds_read_b128 v[180:183], v1 offset:21504
ds_read_b128 v[184:187], v1 offset:35840
ds_read_b128 v[188:191], v1 offset:50176
s_waitcnt lgkmcnt(10)
v_mfma_f32_16x16x32_bf16 v[68:71], v[196:199], v[196:199], v[68:71]
v_mfma_f32_16x16x32_bf16 v[100:103], v[16:19], v[196:199], v[100:103]
s_waitcnt lgkmcnt(9)
v_mfma_f32_16x16x32_bf16 v[72:75], v[200:203], v[200:203], v[72:75]
v_mfma_f32_16x16x32_bf16 v[104:107], v[16:19], v[200:203], v[104:107]
s_waitcnt lgkmcnt(8)
v_mfma_f32_16x16x32_bf16 v[76:79], v[204:207], v[204:207], v[76:79]
v_mfma_f32_16x16x32_bf16 v[108:111], v[16:19], v[204:207], v[108:111]
s_add_u32 m0, s27, 67584
s_add_u32 s6, s26, 67584
buffer_load_dwordx4 v1, s[52:55], s6 offen sc1 lds
s_waitcnt lgkmcnt(7)
v_mfma_f32_16x16x32_bf16 v[64:67], v[160:163], v[160:163], v[64:67]
v_mfma_f32_16x16x32_bf16 v[96:99], v[16:19], v[160:163], v[96:99]
ds_read_b128 v[192:195], v1 offset:8192
ds_read_b128 v[196:199], v1 offset:22528
ds_read_b128 v[200:203], v1 offset:36864
ds_read_b128 v[204:207], v1 offset:51200
s_waitcnt lgkmcnt(10)
v_mfma_f32_16x16x32_bf16 v[68:71], v[164:167], v[164:167], v[68:71]
v_mfma_f32_16x16x32_bf16 v[100:103], v[16:19], v[164:167], v[100:103]
s_waitcnt lgkmcnt(9)
v_mfma_f32_16x16x32_bf16 v[72:75], v[168:171], v[168:171], v[72:75]
v_mfma_f32_16x16x32_bf16 v[104:107], v[16:19], v[168:171], v[104:107]
s_waitcnt lgkmcnt(8)
v_mfma_f32_16x16x32_bf16 v[76:79], v[172:175], v[172:175], v[76:79]
v_mfma_f32_16x16x32_bf16 v[108:111], v[16:19], v[172:175], v[108:111]
s_add_u32 m0, s27, 69632
s_add_u32 s6, s26, 69632
buffer_load_dwordx4 v1, s[52:55], s6 offen sc1 lds
s_waitcnt lgkmcnt(7)
v_mfma_f32_16x16x32_bf16 v[64:67], v[176:179], v[176:179], v[64:67]
v_mfma_f32_16x16x32_bf16 v[96:99], v[16:19], v[176:179], v[96:99]
ds_read_b128 v[160:163], v1 offset:9216
ds_read_b128 v[164:167], v1 offset:23552
ds_read_b128 v[168:171], v1 offset:37888
ds_read_b128 v[172:175], v1 offset:52224
s_waitcnt lgkmcnt(10)
v_mfma_f32_16x16x32_bf16 v[68:71], v[180:183], v[180:183], v[68:71]
v_mfma_f32_16x16x32_bf16 v[100:103], v[16:19], v[180:183], v[100:103]
s_waitcnt lgkmcnt(9)
v_mfma_f32_16x16x32_bf16 v[72:75], v[184:187], v[184:187], v[72:75]
v_mfma_f32_16x16x32_bf16 v[104:107], v[16:19], v[184:187], v[104:107]
s_waitcnt lgkmcnt(8)
v_mfma_f32_16x16x32_bf16 v[76:79], v[188:191], v[188:191], v[76:79]
v_mfma_f32_16x16x32_bf16 v[108:111], v[16:19], v[188:191], v[108:111]
s_waitcnt lgkmcnt(7)
v_mfma_f32_16x16x32_bf16 v[64:67], v[192:195], v[192:195], v[64:67]
v_mfma_f32_16x16x32_bf16 v[96:99], v[16:19], v[192:195], v[96:99]
ds_read_b128 v[176:179], v1 offset:10240
ds_read_b128 v[180:183], v1 offset:24576
ds_read_b128 v[184:187], v1 offset:38912
ds_read_b128 v[188:191], v1 offset:53248
s_waitcnt lgkmcnt(10)
v_mfma_f32_16x16x32_bf16 v[68:71], v[196:199], v[196:199], v[68:71]
v_mfma_f32_16x16x32_bf16 v[100:103], v[16:19], v[196:199], v[100:103]
s_waitcnt lgkmcnt(9)
v_mfma_f32_16x16x32_bf16 v[72:75], v[200:203], v[200:203], v[72:75]
v_mfma_f32_16x16x32_bf16 v[104:107], v[16:19], v[200:203], v[104:107]
s_waitcnt lgkmcnt(8)
v_mfma_f32_16x16x32_bf16 v[76:79], v[204:207], v[204:207], v[76:79]
v_mfma_f32_16x16x32_bf16 v[108:111], v[16:19], v[204:207], v[108:111]
s_waitcnt lgkmcnt(7)
v_mfma_f32_16x16x32_bf16 v[64:67], v[160:163], v[160:163], v[64:67]
v_mfma_f32_16x16x32_bf16 v[96:99], v[16:19], v[160:163], v[96:99]
ds_read_b128 v[192:195], v1 offset:11264
ds_read_b128 v[196:199], v1 offset:25600
ds_read_b128 v[200:203], v1 offset:39936
ds_read_b128 v[204:207], v1 offset:54272
s_waitcnt lgkmcnt(10)
v_mfma_f32_16x16x32_bf16 v[68:71], v[164:167], v[164:167], v[68:71]
v_mfma_f32_16x16x32_bf16 v[100:103], v[16:19], v[164:167], v[100:103]
s_waitcnt lgkmcnt(9)
v_mfma_f32_16x16x32_bf16 v[72:75], v[168:171], v[168:171], v[72:75]
v_mfma_f32_16x16x32_bf16 v[104:107], v[16:19], v[168:171], v[104:107]
s_waitcnt lgkmcnt(8)
v_mfma_f32_16x16x32_bf16 v[76:79], v[172:175], v[172:175], v[76:79]
v_mfma_f32_16x16x32_bf16 v[108:111], v[16:19], v[172:175], v[108:111]
s_waitcnt lgkmcnt(7)
v_mfma_f32_16x16x32_bf16 v[64:67], v[176:179], v[176:179], v[64:67]
v_mfma_f32_16x16x32_bf16 v[96:99], v[16:19], v[176:179], v[96:99]
ds_read_b128 v[160:163], v1 offset:12288
ds_read_b128 v[164:167], v1 offset:26624
ds_read_b128 v[168:171], v1 offset:40960
ds_read_b128 v[172:175], v1 offset:55296
s_waitcnt lgkmcnt(10)
v_mfma_f32_16x16x32_bf16 v[68:71], v[180:183], v[180:183], v[68:71]
v_mfma_f32_16x16x32_bf16 v[100:103], v[16:19], v[180:183], v[100:103]
s_waitcnt lgkmcnt(9)
v_mfma_f32_16x16x32_bf16 v[72:75], v[184:187], v[184:187], v[72:75]
v_mfma_f32_16x16x32_bf16 v[104:107], v[16:19], v[184:187], v[104:107]
s_waitcnt lgkmcnt(8)
v_mfma_f32_16x16x32_bf16 v[76:79], v[188:191], v[188:191], v[76:79]
v_mfma_f32_16x16x32_bf16 v[108:111], v[16:19], v[188:191], v[108:111]
s_waitcnt lgkmcnt(7)
v_mfma_f32_16x16x32_bf16 v[64:67], v[192:195], v[192:195], v[64:67]
v_mfma_f32_16x16x32_bf16 v[96:99], v[16:19], v[192:195], v[96:99]
ds_read_b128 v[176:179], v1 offset:13312
ds_read_b128 v[180:183], v1 offset:27648
ds_read_b128 v[184:187], v1 offset:41984
ds_read_b128 v[188:191], v1 offset:56320
s_waitcnt lgkmcnt(10)
v_mfma_f32_16x16x32_bf16 v[68:71], v[196:199], v[196:199], v[68:71]
v_mfma_f32_16x16x32_bf16 v[100:103], v[16:19], v[196:199], v[100:103]
s_waitcnt lgkmcnt(9)
v_mfma_f32_16x16x32_bf16 v[72:75], v[200:203], v[200:203], v[72:75]
v_mfma_f32_16x16x32_bf16 v[104:107], v[16:19], v[200:203], v[104:107]
s_waitcnt lgkmcnt(8)
v_mfma_f32_16x16x32_bf16 v[76:79], v[204:207], v[204:207], v[76:79]
v_mfma_f32_16x16x32_bf16 v[108:111], v[16:19], v[204:207], v[108:111]
s_waitcnt lgkmcnt(7)
v_mfma_f32_16x16x32_bf16 v[64:67], v[160:163], v[160:163], v[64:67]
v_mfma_f32_16x16x32_bf16 v[96:99], v[16:19], v[160:163], v[96:99]
s_waitcnt vmcnt(0)
s_barrier
ds_read_b128 v[192:195], v2 offset:0
ds_read_b128 v[196:199], v2 offset:14336
ds_read_b128 v[200:203], v2 offset:28672
ds_read_b128 v[204:207], v2 offset:43008
s_waitcnt lgkmcnt(10)
v_mfma_f32_16x16x32_bf16 v[68:71], v[164:167], v[164:167], v[68:71]
v_mfma_f32_16x16x32_bf16 v[100:103], v[16:19], v[164:167], v[100:103]
s_waitcnt lgkmcnt(9)
v_mfma_f32_16x16x32_bf16 v[72:75], v[168:171], v[168:171], v[72:75]
v_mfma_f32_16x16x32_bf16 v[104:107], v[16:19], v[168:171], v[104:107]
s_waitcnt lgkmcnt(8)
v_mfma_f32_16x16x32_bf16 v[76:79], v[172:175], v[172:175], v[76:79]
v_mfma_f32_16x16x32_bf16 v[108:111], v[16:19], v[172:175], v[108:111]
s_waitcnt lgkmcnt(7)
v_mfma_f32_16x16x32_bf16 v[64:67], v[176:179], v[176:179], v[64:67]
v_mfma_f32_16x16x32_bf16 v[96:99], v[16:19], v[176:179], v[96:99]
ds_read_b128 v[160:163], v2 offset:1024
ds_read_b128 v[164:167], v2 offset:15360
ds_read_b128 v[168:171], v2 offset:29696
ds_read_b128 v[172:175], v2 offset:44032
s_waitcnt lgkmcnt(10)
v_mfma_f32_16x16x32_bf16 v[68:71], v[180:183], v[180:183], v[68:71]
v_mfma_f32_16x16x32_bf16 v[100:103], v[16:19], v[180:183], v[100:103]
s_waitcnt lgkmcnt(9)
v_mfma_f32_16x16x32_bf16 v[72:75], v[184:187], v[184:187], v[72:75]
v_mfma_f32_16x16x32_bf16 v[104:107], v[16:19], v[184:187], v[104:107]
s_waitcnt lgkmcnt(8)
v_mfma_f32_16x16x32_bf16 v[76:79], v[188:191], v[188:191], v[76:79]
v_mfma_f32_16x16x32_bf16 v[108:111], v[16:19], v[188:191], v[108:111]
v_cndmask_b32 v4, v64, v65, s[76:77]
v_cndmask_b32 v4, v4, v66, s[78:79]
v_cndmask_b32 v4, v4, v67, s[80:81]
v_mul_f32 v128, 0xbb124925, v96
v_mul_f32 v4, 0x3b124925, v4
v_fma_f32 v4, -v128, v128, v4
v_max_f32 v4, 0, v4
v_add_f32 v130, 0x3727c5ac, v4
v_rsq_f32 v4, v130
s_nop 0
v_mul_f32 v129, 0xbfb8aa3b, v4
v_mov_b32 v131, 0
v_cndmask_b32 v4, v68, v69, s[76:77]
v_cndmask_b32 v4, v4, v70, s[78:79]
v_cndmask_b32 v4, v4, v71, s[80:81]
v_mul_f32 v132, 0xbb124925, v100
v_mul_f32 v4, 0x3b124925, v4
v_fma_f32 v4, -v132, v132, v4
v_max_f32 v4, 0, v4
v_add_f32 v134, 0x3727c5ac, v4
v_rsq_f32 v4, v134
s_nop 0
v_mul_f32 v133, 0xbfb8aa3b, v4
v_mov_b32 v135, 0
v_cndmask_b32 v4, v72, v73, s[76:77]
v_cndmask_b32 v4, v4, v74, s[78:79]
v_cndmask_b32 v4, v4, v75, s[80:81]
v_mul_f32 v136, 0xbb124925, v104
v_mul_f32 v4, 0x3b124925, v4
v_fma_f32 v4, -v136, v136, v4
v_max_f32 v4, 0, v4
v_add_f32 v138, 0x3727c5ac, v4
v_rsq_f32 v4, v138
s_nop 0
v_mul_f32 v137, 0xbfb8aa3b, v4
v_mov_b32 v139, 0
v_cndmask_b32 v4, v76, v77, s[76:77]
v_cndmask_b32 v4, v4, v78, s[78:79]
v_cndmask_b32 v4, v4, v79, s[80:81]
v_mul_f32 v140, 0xbb124925, v108
v_mul_f32 v4, 0x3b124925, v4
v_fma_f32 v4, -v140, v140, v4
v_max_f32 v4, 0, v4
v_add_f32 v142, 0x3727c5ac, v4
v_rsq_f32 v4, v142
s_nop 0
v_mul_f32 v141, 0xbfb8aa3b, v4
v_mov_b32 v143, 0
s_mov_b64 exec, s[82:83]
ds_write_b128 v9, v[128:131] offset:0
ds_write_b128 v9, v[132:135] offset:256
ds_write_b128 v9, v[136:139] offset:512
ds_write_b128 v9, v[140:143] offset:768
s_mov_b64 exec, -1
v_mov_b32 v4, 1
s_waitcnt lgkmcnt(0)
ds_write_b32 v11, v4 offset:4
v_mfma_f32_16x16x32_bf16 v[80:83], v[192:195], v[192:195], 0
v_mfma_f32_16x16x32_bf16 v[112:115], v[16:19], v[192:195], 0
ds_read_b128 v[176:179], v2 offset:2048
ds_read_b128 v[180:183], v2 offset:16384
ds_read_b128 v[184:187], v2 offset:30720
ds_read_b128 v[188:191], v2 offset:45056
v_mfma_f32_16x16x32_bf16 v[84:87], v[196:199], v[196:199], 0
v_mfma_f32_16x16x32_bf16 v[116:119], v[16:19], v[196:199], 0
v_mfma_f32_16x16x32_bf16 v[88:91], v[200:203], v[200:203], 0
v_mfma_f32_16x16x32_bf16 v[120:123], v[16:19], v[200:203], 0
v_mfma_f32_16x16x32_bf16 v[92:95], v[204:207], v[204:207], 0
v_mfma_f32_16x16x32_bf16 v[124:127], v[16:19], v[204:207], 0
v_mfma_f32_16x16x32_bf16 v[80:83], v[160:163], v[160:163], v[80:83]
v_mfma_f32_16x16x32_bf16 v[112:115], v[16:19], v[160:163], v[112:115]
ds_read_b128 v[192:195], v2 offset:3072
ds_read_b128 v[196:199], v2 offset:17408
ds_read_b128 v[200:203], v2 offset:31744
ds_read_b128 v[204:207], v2 offset:46080
v_mfma_f32_16x16x32_bf16 v[84:87], v[164:167], v[164:167], v[84:87]
v_mfma_f32_16x16x32_bf16 v[116:119], v[16:19], v[164:167], v[116:119]
v_mfma_f32_16x16x32_bf16 v[88:91], v[168:171], v[168:171], v[88:91]
v_mfma_f32_16x16x32_bf16 v[120:123], v[16:19], v[168:171], v[120:123]
v_mfma_f32_16x16x32_bf16 v[92:95], v[172:175], v[172:175], v[92:95]
v_mfma_f32_16x16x32_bf16 v[124:127], v[16:19], v[172:175], v[124:127]
s_waitcnt lgkmcnt(7)
v_mfma_f32_16x16x32_bf16 v[80:83], v[176:179], v[176:179], v[80:83]
v_mfma_f32_16x16x32_bf16 v[112:115], v[16:19], v[176:179], v[112:115]
ds_read_b128 v[160:163], v2 offset:4096
ds_read_b128 v[164:167], v2 offset:18432
ds_read_b128 v[168:171], v2 offset:32768
ds_read_b128 v[172:175], v2 offset:47104
s_waitcnt lgkmcnt(10)
v_mfma_f32_16x16x32_bf16 v[84:87], v[180:183], v[180:183], v[84:87]
v_mfma_f32_16x16x32_bf16 v[116:119], v[16:19], v[180:183], v[116:119]
s_waitcnt lgkmcnt(9)
v_mfma_f32_16x16x32_bf16 v[88:91], v[184:187], v[184:187], v[88:91]
v_mfma_f32_16x16x32_bf16 v[120:123], v[16:19], v[184:187], v[120:123]
s_waitcnt lgkmcnt(8)
v_mfma_f32_16x16x32_bf16 v[92:95], v[188:191], v[188:191], v[92:95]
v_mfma_f32_16x16x32_bf16 v[124:127], v[16:19], v[188:191], v[124:127]
s_waitcnt lgkmcnt(7)
v_mfma_f32_16x16x32_bf16 v[80:83], v[192:195], v[192:195], v[80:83]
v_mfma_f32_16x16x32_bf16 v[112:115], v[16:19], v[192:195], v[112:115]
ds_read_b128 v[176:179], v2 offset:5120
ds_read_b128 v[180:183], v2 offset:19456
ds_read_b128 v[184:187], v2 offset:33792
ds_read_b128 v[188:191], v2 offset:48128
s_waitcnt lgkmcnt(10)
v_mfma_f32_16x16x32_bf16 v[84:87], v[196:199], v[196:199], v[84:87]
v_mfma_f32_16x16x32_bf16 v[116:119], v[16:19], v[196:199], v[116:119]
s_waitcnt lgkmcnt(9)
v_mfma_f32_16x16x32_bf16 v[88:91], v[200:203], v[200:203], v[88:91]
v_mfma_f32_16x16x32_bf16 v[120:123], v[16:19], v[200:203], v[120:123]
s_waitcnt lgkmcnt(8)
v_mfma_f32_16x16x32_bf16 v[92:95], v[204:207], v[204:207], v[92:95]
v_mfma_f32_16x16x32_bf16 v[124:127], v[16:19], v[204:207], v[124:127]
s_waitcnt lgkmcnt(7)
v_mfma_f32_16x16x32_bf16 v[80:83], v[160:163], v[160:163], v[80:83]
v_mfma_f32_16x16x32_bf16 v[112:115], v[16:19], v[160:163], v[112:115]
ds_read_b128 v[192:195], v2 offset:6144
ds_read_b128 v[196:199], v2 offset:20480
ds_read_b128 v[200:203], v2 offset:34816
ds_read_b128 v[204:207], v2 offset:49152
s_waitcnt lgkmcnt(10)
v_mfma_f32_16x16x32_bf16 v[84:87], v[164:167], v[164:167], v[84:87]
v_mfma_f32_16x16x32_bf16 v[116:119], v[16:19], v[164:167], v[116:119]
s_waitcnt lgkmcnt(9)
v_mfma_f32_16x16x32_bf16 v[88:91], v[168:171], v[168:171], v[88:91]
v_mfma_f32_16x16x32_bf16 v[120:123], v[16:19], v[168:171], v[120:123]
s_waitcnt lgkmcnt(8)
v_mfma_f32_16x16x32_bf16 v[92:95], v[172:175], v[172:175], v[92:95]
v_mfma_f32_16x16x32_bf16 v[124:127], v[16:19], v[172:175], v[124:127]
s_waitcnt lgkmcnt(7)
v_mfma_f32_16x16x32_bf16 v[80:83], v[176:179], v[176:179], v[80:83]
v_mfma_f32_16x16x32_bf16 v[112:115], v[16:19], v[176:179], v[112:115]
ds_read_b128 v[160:163], v2 offset:7168
ds_read_b128 v[164:167], v2 offset:21504
ds_read_b128 v[168:171], v2 offset:35840
ds_read_b128 v[172:175], v2 offset:50176
s_waitcnt lgkmcnt(10)
v_mfma_f32_16x16x32_bf16 v[84:87], v[180:183], v[180:183], v[84:87]
v_mfma_f32_16x16x32_bf16 v[116:119], v[16:19], v[180:183], v[116:119]
s_waitcnt lgkmcnt(9)
v_mfma_f32_16x16x32_bf16 v[88:91], v[184:187], v[184:187], v[88:91]
v_mfma_f32_16x16x32_bf16 v[120:123], v[16:19], v[184:187], v[120:123]
s_waitcnt lgkmcnt(8)
v_mfma_f32_16x16x32_bf16 v[92:95], v[188:191], v[188:191], v[92:95]
v_mfma_f32_16x16x32_bf16 v[124:127], v[16:19], v[188:191], v[124:127]
s_waitcnt lgkmcnt(7)
v_mfma_f32_16x16x32_bf16 v[80:83], v[192:195], v[192:195], v[80:83]
v_mfma_f32_16x16x32_bf16 v[112:115], v[16:19], v[192:195], v[112:115]
ds_read_b128 v[176:179], v2 offset:8192
ds_read_b128 v[180:183], v2 offset:22528
ds_read_b128 v[184:187], v2 offset:36864
ds_read_b128 v[188:191], v2 offset:51200
s_waitcnt lgkmcnt(10)
v_mfma_f32_16x16x32_bf16 v[84:87], v[196:199], v[196:199], v[84:87]
v_mfma_f32_16x16x32_bf16 v[116:119], v[16:19], v[196:199], v[116:119]
s_waitcnt lgkmcnt(9)
v_mfma_f32_16x16x32_bf16 v[88:91], v[200:203], v[200:203], v[88:91]
v_mfma_f32_16x16x32_bf16 v[120:123], v[16:19], v[200:203], v[120:123]
s_waitcnt lgkmcnt(8)
v_mfma_f32_16x16x32_bf16 v[92:95], v[204:207], v[204:207], v[92:95]
v_mfma_f32_16x16x32_bf16 v[124:127], v[16:19], v[204:207], v[124:127]
s_waitcnt lgkmcnt(7)
v_mfma_f32_16x16x32_bf16 v[80:83], v[160:163], v[160:163], v[80:83]
v_mfma_f32_16x16x32_bf16 v[112:115], v[16:19], v[160:163], v[112:115]
ds_read_b128 v[192:195], v2 offset:9216
ds_read_b128 v[196:199], v2 offset:23552
ds_read_b128 v[200:203], v2 offset:37888
ds_read_b128 v[204:207], v2 offset:52224
s_waitcnt lgkmcnt(10)
v_mfma_f32_16x16x32_bf16 v[84:87], v[164:167], v[164:167], v[84:87]
v_mfma_f32_16x16x32_bf16 v[116:119], v[16:19], v[164:167], v[116:119]
s_waitcnt lgkmcnt(9)
v_mfma_f32_16x16x32_bf16 v[88:91], v[168:171], v[168:171], v[88:91]
v_mfma_f32_16x16x32_bf16 v[120:123], v[16:19], v[168:171], v[120:123]
s_waitcnt lgkmcnt(8)
v_mfma_f32_16x16x32_bf16 v[92:95], v[172:175], v[172:175], v[92:95]
v_mfma_f32_16x16x32_bf16 v[124:127], v[16:19], v[172:175], v[124:127]
s_waitcnt lgkmcnt(7)
v_mfma_f32_16x16x32_bf16 v[80:83], v[176:179], v[176:179], v[80:83]
v_mfma_f32_16x16x32_bf16 v[112:115], v[16:19], v[176:179], v[112:115]
ds_read_b128 v[160:163], v2 offset:10240
ds_read_b128 v[164:167], v2 offset:24576
ds_read_b128 v[168:171], v2 offset:38912
ds_read_b128 v[172:175], v2 offset:53248
s_waitcnt lgkmcnt(10)
v_mfma_f32_16x16x32_bf16 v[84:87], v[180:183], v[180:183], v[84:87]
v_mfma_f32_16x16x32_bf16 v[116:119], v[16:19], v[180:183], v[116:119]
s_waitcnt lgkmcnt(9)
v_mfma_f32_16x16x32_bf16 v[88:91], v[184:187], v[184:187], v[88:91]
v_mfma_f32_16x16x32_bf16 v[120:123], v[16:19], v[184:187], v[120:123]
s_waitcnt lgkmcnt(8)
v_mfma_f32_16x16x32_bf16 v[92:95], v[188:191], v[188:191], v[92:95]
v_mfma_f32_16x16x32_bf16 v[124:127], v[16:19], v[188:191], v[124:127]
s_waitcnt lgkmcnt(7)
v_mfma_f32_16x16x32_bf16 v[80:83], v[192:195], v[192:195], v[80:83]
v_mfma_f32_16x16x32_bf16 v[112:115], v[16:19], v[192:195], v[112:115]
ds_read_b128 v[176:179], v2 offset:11264
ds_read_b128 v[180:183], v2 offset:25600
ds_read_b128 v[184:187], v2 offset:39936
ds_read_b128 v[188:191], v2 offset:54272
s_waitcnt lgkmcnt(10)
v_mfma_f32_16x16x32_bf16 v[84:87], v[196:199], v[196:199], v[84:87]
v_mfma_f32_16x16x32_bf16 v[116:119], v[16:19], v[196:199], v[116:119]
s_waitcnt lgkmcnt(9)
v_mfma_f32_16x16x32_bf16 v[88:91], v[200:203], v[200:203], v[88:91]
v_mfma_f32_16x16x32_bf16 v[120:123], v[16:19], v[200:203], v[120:123]
s_waitcnt lgkmcnt(8)
v_mfma_f32_16x16x32_bf16 v[92:95], v[204:207], v[204:207], v[92:95]
v_mfma_f32_16x16x32_bf16 v[124:127], v[16:19], v[204:207], v[124:127]
s_waitcnt lgkmcnt(7)
v_mfma_f32_16x16x32_bf16 v[80:83], v[160:163], v[160:163], v[80:83]
v_mfma_f32_16x16x32_bf16 v[112:115], v[16:19], v[160:163], v[112:115]
ds_read_b128 v[192:195], v2 offset:12288
ds_read_b128 v[196:199], v2 offset:26624
ds_read_b128 v[200:203], v2 offset:40960
ds_read_b128 v[204:207], v2 offset:55296
s_waitcnt lgkmcnt(10)
v_mfma_f32_16x16x32_bf16 v[84:87], v[164:167], v[164:167], v[84:87]
v_mfma_f32_16x16x32_bf16 v[116:119], v[16:19], v[164:167], v[116:119]
s_waitcnt lgkmcnt(9)
v_mfma_f32_16x16x32_bf16 v[88:91], v[168:171], v[168:171], v[88:91]
v_mfma_f32_16x16x32_bf16 v[120:123], v[16:19], v[168:171], v[120:123]
s_waitcnt lgkmcnt(8)
v_mfma_f32_16x16x32_bf16 v[92:95], v[172:175], v[172:175], v[92:95]
v_mfma_f32_16x16x32_bf16 v[124:127], v[16:19], v[172:175], v[124:127]
s_waitcnt lgkmcnt(7)
v_mfma_f32_16x16x32_bf16 v[80:83], v[176:179], v[176:179], v[80:83]
v_mfma_f32_16x16x32_bf16 v[112:115], v[16:19], v[176:179], v[112:115]
ds_read_b128 v[160:163], v2 offset:13312
ds_read_b128 v[164:167], v2 offset:27648
ds_read_b128 v[168:171], v2 offset:41984
ds_read_b128 v[172:175], v2 offset:56320
s_waitcnt lgkmcnt(10)
v_mfma_f32_16x16x32_bf16 v[84:87], v[180:183], v[180:183], v[84:87]
v_mfma_f32_16x16x32_bf16 v[116:119], v[16:19], v[180:183], v[116:119]
s_waitcnt lgkmcnt(9)
v_mfma_f32_16x16x32_bf16 v[88:91], v[184:187], v[184:187], v[88:91]
v_mfma_f32_16x16x32_bf16 v[120:123], v[16:19], v[184:187], v[120:123]
s_waitcnt lgkmcnt(8)
v_mfma_f32_16x16x32_bf16 v[92:95], v[188:191], v[188:191], v[92:95]
v_mfma_f32_16x16x32_bf16 v[124:127], v[16:19], v[188:191], v[124:127]
s_waitcnt lgkmcnt(7)
v_mfma_f32_16x16x32_bf16 v[80:83], v[192:195], v[192:195], v[80:83]
v_mfma_f32_16x16x32_bf16 v[112:115], v[16:19], v[192:195], v[112:115]
s_waitcnt lgkmcnt(6)
v_mfma_f32_16x16x32_bf16 v[84:87], v[196:199], v[196:199], v[84:87]
v_mfma_f32_16x16x32_bf16 v[116:119], v[16:19], v[196:199], v[116:119]
s_waitcnt lgkmcnt(5)
v_mfma_f32_16x16x32_bf16 v[88:91], v[200:203], v[200:203], v[88:91]
v_mfma_f32_16x16x32_bf16 v[120:123], v[16:19], v[200:203], v[120:123]
s_waitcnt lgkmcnt(4)
v_mfma_f32_16x16x32_bf16 v[92:95], v[204:207], v[204:207], v[92:95]
v_mfma_f32_16x16x32_bf16 v[124:127], v[16:19], v[204:207], v[124:127]
s_waitcnt lgkmcnt(3)
v_mfma_f32_16x16x32_bf16 v[80:83], v[160:163], v[160:163], v[80:83]
v_mfma_f32_16x16x32_bf16 v[112:115], v[16:19], v[160:163], v[112:115]
s_waitcnt lgkmcnt(2)
v_mfma_f32_16x16x32_bf16 v[84:87], v[164:167], v[164:167], v[84:87]
v_mfma_f32_16x16x32_bf16 v[116:119], v[16:19], v[164:167], v[116:119]
s_waitcnt lgkmcnt(1)
v_mfma_f32_16x16x32_bf16 v[88:91], v[168:171], v[168:171], v[88:91]
v_mfma_f32_16x16x32_bf16 v[120:123], v[16:19], v[168:171], v[120:123]
s_waitcnt lgkmcnt(0)
v_mfma_f32_16x16x32_bf16 v[92:95], v[172:175], v[172:175], v[92:95]
v_mfma_f32_16x16x32_bf16 v[124:127], v[16:19], v[172:175], v[124:127]
v_cndmask_b32 v4, v80, v81, s[76:77]
v_cndmask_b32 v4, v4, v82, s[78:79]
v_cndmask_b32 v4, v4, v83, s[80:81]
v_mul_f32 v128, 0xbb124925, v112
v_mul_f32 v4, 0x3b124925, v4
v_fma_f32 v4, -v128, v128, v4
v_max_f32 v4, 0, v4
v_add_f32 v130, 0x3727c5ac, v4
v_rsq_f32 v4, v130
s_nop 0
v_mul_f32 v129, 0xbfb8aa3b, v4
v_mov_b32 v131, 0
v_cndmask_b32 v4, v84, v85, s[76:77]
v_cndmask_b32 v4, v4, v86, s[78:79]
v_cndmask_b32 v4, v4, v87, s[80:81]
v_mul_f32 v132, 0xbb124925, v116
v_mul_f32 v4, 0x3b124925, v4
v_fma_f32 v4, -v132, v132, v4
v_max_f32 v4, 0, v4
v_add_f32 v134, 0x3727c5ac, v4
v_rsq_f32 v4, v134
s_nop 0
v_mul_f32 v133, 0xbfb8aa3b, v4
v_mov_b32 v135, 0
v_cndmask_b32 v4, v88, v89, s[76:77]
v_cndmask_b32 v4, v4, v90, s[78:79]
v_cndmask_b32 v4, v4, v91, s[80:81]
v_mul_f32 v136, 0xbb124925, v120
v_mul_f32 v4, 0x3b124925, v4
v_fma_f32 v4, -v136, v136, v4
v_max_f32 v4, 0, v4
v_add_f32 v138, 0x3727c5ac, v4
v_rsq_f32 v4, v138
s_nop 0
v_mul_f32 v137, 0xbfb8aa3b, v4
v_mov_b32 v139, 0
v_cndmask_b32 v4, v92, v93, s[76:77]
v_cndmask_b32 v4, v4, v94, s[78:79]
v_cndmask_b32 v4, v4, v95, s[80:81]
v_mul_f32 v140, 0xbb124925, v124
v_mul_f32 v4, 0x3b124925, v4
v_fma_f32 v4, -v140, v140, v4
v_max_f32 v4, 0, v4
v_add_f32 v142, 0x3727c5ac, v4
v_rsq_f32 v4, v142
s_nop 0
v_mul_f32 v141, 0xbfb8aa3b, v4
v_mov_b32 v143, 0
s_mov_b64 exec, s[82:83]
ds_write_b128 v9, v[128:131] offset:1024
ds_write_b128 v9, v[132:135] offset:1280
ds_write_b128 v9, v[136:139] offset:1536
ds_write_b128 v9, v[140:143] offset:1792
s_mov_b64 exec, -1
v_mov_b32 v4, 2
s_waitcnt lgkmcnt(0)
ds_write_b32 v11, v4 offset:4
s_waitcnt lgkmcnt(0)
s_mov_b32 exec_lo, 0x0
s_mov_b32 exec_hi, 0xffff0000
s_mov_b32 s4, 0x18000
s_mov_b32 s10, 0
L81:
buffer_load_dwordx2 v[26:27], v13, s[52:55], s4 offen sc1
s_add_u32 s10, s10, 1
s_cmp_lg_u32 s10, 0x1000
s_cbranch_scc1 L83
v_and_b32 v13, 0x7ffff, v13
L83:
s_cmp_gt_u32 s10, 0x40000
s_waitcnt vmcnt(0)
s_cbranch_scc1 L82
v_cmp_ne_u64 vcc, v[26:27], v[24:25]
s_cbranch_vccnz L81
L82:
s_mov_b64 exec, -1
s_mov_b32 s10, 0
L84:
ds_read_b32 v12, v11 offset:8
s_add_u32 s10, s10, 1
s_cmp_gt_u32 s10, 0x100000
s_waitcnt lgkmcnt(0)
s_cbranch_scc1 L85
v_cmp_gt_u32 vcc, 7, v12
s_cbranch_vccnz L84
L85:
s_add_u32 s4, s23, 0
s_mul_i32 s4, s4, 57344
s_add_u32 s4, s4, 0x1000000
s_mov_b32 m0, 51200
s_add_u32 s6, s4, 51200
buffer_load_dwordx4 v1, s[52:55], s6 offen offset:0 sc1 lds
buffer_load_dwordx4 v1, s[52:55], s6 offen offset:1024 sc1 lds
buffer_load_dwordx4 v1, s[52:55], s6 offen offset:2048 sc1 lds
buffer_load_dwordx4 v1, s[52:55], s6 offen offset:3072 sc1 lds
s_mov_b32 m0, 55296
s_add_u32 s6, s4, 55296
buffer_load_dwordx4 v1, s[52:55], s6 offen offset:0 sc1 lds
buffer_load_dwordx4 v1, s[52:55], s6 offen offset:1024 sc1 lds
s_mov_b32 m0, 0
s_add_u32 s6, s4, 0
buffer_load_dwordx4 v1, s[52:55], s6 offen offset:0 sc1 lds
buffer_load_dwordx4 v1, s[52:55], s6 offen offset:1024 sc1 lds
buffer_load_dwordx4 v1, s[52:55], s6 offen offset:2048 sc1 lds
buffer_load_dwordx4 v1, s[52:55], s6 offen offset:3072 sc1 lds
s_mov_b32 m0, 4096
s_add_u32 s6, s4, 4096
buffer_load_dwordx4 v1, s[52:55], s6 offen offset:0 sc1 lds
buffer_load_dwordx4 v1, s[52:55], s6 offen offset:1024 sc1 lds
buffer_load_dwordx4 v1, s[52:55], s6 offen offset:2048 sc1 lds
buffer_load_dwordx4 v1, s[52:55], s6 offen offset:3072 sc1 lds
s_mov_b32 m0, 8192
s_add_u32 s6, s4, 8192
buffer_load_dwordx4 v1, s[52:55], s6 offen offset:0 sc1 lds
buffer_load_dwordx4 v1, s[52:55], s6 offen offset:1024 sc1 lds
buffer_load_dwordx4 v1, s[52:55], s6 offen offset:2048 sc1 lds
buffer_load_dwordx4 v1, s[52:55], s6 offen offset:3072 sc1 lds
s_mov_b32 m0, 12288
s_add_u32 s6, s4, 12288
buffer_load_dwordx4 v1, s[52:55], s6 offen offset:0 sc1 lds
buffer_load_dwordx4 v1, s[52:55], s6 offen offset:1024 sc1 lds
buffer_load_dwordx4 v1, s[52:55], s6 offen offset:2048 sc1 lds
buffer_load_dwordx4 v1, s[52:55], s6 offen offset:3072 sc1 lds
s_mov_b32 m0, 16384
s_add_u32 s6, s4, 16384
buffer_load_dwordx4 v1, s[52:55], s6 offen offset:0 sc1 lds
buffer_load_dwordx4 v1, s[52:55], s6 offen offset:1024 sc1 lds
buffer_load_dwordx4 v1, s[52:55], s6 offen offset:2048 sc1 lds
buffer_load_dwordx4 v1, s[52:55], s6 offen offset:3072 sc1 lds
s_mov_b32 m0, 20480
s_add_u32 s6, s4, 20480
buffer_load_dwordx4 v1, s[52:55], s6 offen offset:0 sc1 lds
buffer_load_dwordx4 v1, s[52:55], s6 offen offset:1024 sc1 lds
buffer_load_dwordx4 v1, s[52:55], s6 offen offset:2048 sc1 lds
buffer_load_dwordx4 v1, s[52:55], s6 offen offset:3072 sc1 lds
s_mov_b32 m0, 24576
s_add_u32 s6, s4, 24576
buffer_load_dwordx4 v1, s[52:55], s6 offen offset:0 sc1 lds
buffer_load_dwordx4 v1, s[52:55], s6 offen offset:1024 sc1 lds
s_mov_b32 m0, 36864
s_add_u32 s6, s4, 36864
buffer_load_dwordx4 v1, s[52:55], s6 offen offset:0 sc1 lds
buffer_load_dwordx4 v1, s[52:55], s6 offen offset:1024 sc1 lds
buffer_load_dwordx4 v1, s[52:55], s6 offen offset:2048 sc1 lds
buffer_load_dwordx4 v1, s[52:55], s6 offen offset:3072 sc1 lds
s_mov_b32 m0, 40960
s_add_u32 s6, s4, 40960
buffer_load_dwordx4 v1, s[52:55], s6 offen offset:0 sc1 lds
buffer_load_dwordx4 v1, s[52:55], s6 offen offset:1024 sc1 lds
buffer_load_dwordx4 v1, s[52:55], s6 offen offset:2048 sc1 lds
buffer_load_dwordx4 v1, s[52:55], s6 offen offset:3072 sc1 lds
s_mov_b32 m0, 26624
s_add_u32 s6, s4, 26624
buffer_load_dwordx4 v1, s[52:55], s6 offen offset:0 sc1 lds
buffer_load_dwordx4 v1, s[52:55], s6 offen offset:1024 sc1 lds
buffer_load_dwordx4 v1, s[52:55], s6 offen offset:2048 sc1 lds
buffer_load_dwordx4 v1, s[52:55], s6 offen offset:3072 sc1 lds
s_mov_b32 m0, 30720
s_add_u32 s6, s4, 30720
buffer_load_dwordx4 v1, s[52:55], s6 offen offset:0 sc1 lds
buffer_load_dwordx4 v1, s[52:55], s6 offen offset:1024 sc1 lds
buffer_load_dwordx4 v1, s[52:55], s6 offen offset:2048 sc1 lds
buffer_load_dwordx4 v1, s[52:55], s6 offen offset:3072 sc1 lds
s_mov_b32 m0, 34816
s_add_u32 s6, s4, 34816
buffer_load_dwordx4 v1, s[52:55], s6 offen offset:0 sc1 lds
buffer_load_dwordx4 v1, s[52:55], s6 offen offset:1024 sc1 lds
s_mov_b32 m0, 45056
s_add_u32 s6, s4, 45056
buffer_load_dwordx4 v1, s[52:55], s6 offen offset:0 sc1 lds
buffer_load_dwordx4 v1, s[52:55], s6 offen offset:1024 sc1 lds
buffer_load_dwordx4 v1, s[52:55], s6 offen offset:2048 sc1 lds
buffer_load_dwordx4 v1, s[52:55], s6 offen offset:3072 sc1 lds
s_mov_b32 m0, 49152
s_add_u32 s6, s4, 49152
buffer_load_dwordx4 v1, s[52:55], s6 offen offset:0 sc1 lds
buffer_load_dwordx4 v1, s[52:55], s6 offen offset:1024 sc1 lds
s_waitcnt vmcnt(0)
s_barrier
s_mov_b32 exec_lo, 0x0
s_mov_b32 exec_hi, 0xffff0000
s_mov_b32 s4, 0x28000
s_mov_b32 s10, 0
L86:
buffer_load_dwordx2 v[26:27], v13, s[52:55], s4 offen sc1
s_add_u32 s10, s10, 1
s_cmp_lg_u32 s10, 0x1000
s_cbranch_scc1 L88
v_and_b32 v13, 0x7ffff, v13
L88:
s_cmp_gt_u32 s10, 0x40000
s_waitcnt vmcnt(0)
s_cbranch_scc1 L87
v_cmp_ne_u64 vcc, v[26:27], v[24:25]
s_cbranch_vccnz L86
L87:
s_mov_b64 exec, -1
s_add_u32 s4, s23, 4
s_mul_i32 s4, s4, 57344
s_add_u32 s4, s4, 0x1000000
s_mov_b32 m0, 108544
s_add_u32 s6, s4, 51200
buffer_load_dwordx4 v1, s[52:55], s6 offen offset:0 sc1 lds
buffer_load_dwordx4 v1, s[52:55], s6 offen offset:1024 sc1 lds
buffer_load_dwordx4 v1, s[52:55], s6 offen offset:2048 sc1 lds
buffer_load_dwordx4 v1, s[52:55], s6 offen offset:3072 sc1 lds
s_mov_b32 m0, 112640
s_add_u32 s6, s4, 55296
buffer_load_dwordx4 v1, s[52:55], s6 offen offset:0 sc1 lds
buffer_load_dwordx4 v1, s[52:55], s6 offen offset:1024 sc1 lds
s_mov_b32 m0, 57344
s_add_u32 s6, s4, 0
buffer_load_dwordx4 v1, s[52:55], s6 offen offset:0 sc1 lds
buffer_load_dwordx4 v1, s[52:55], s6 offen offset:1024 sc1 lds
buffer_load_dwordx4 v1, s[52:55], s6 offen offset:2048 sc1 lds
buffer_load_dwordx4 v1, s[52:55], s6 offen offset:3072 sc1 lds
s_mov_b32 m0, 61440
s_add_u32 s6, s4, 4096
buffer_load_dwordx4 v1, s[52:55], s6 offen offset:0 sc1 lds
buffer_load_dwordx4 v1, s[52:55], s6 offen offset:1024 sc1 lds
buffer_load_dwordx4 v1, s[52:55], s6 offen offset:2048 sc1 lds
buffer_load_dwordx4 v1, s[52:55], s6 offen offset:3072 sc1 lds
s_add_u32 s4, s23, 4
s_mul_i32 s4, s4, 57344
s_add_u32 s4, s4, 0x1000000
s_mov_b32 m0, 65536
s_add_u32 s6, s4, 8192
buffer_load_dwordx4 v1, s[52:55], s6 offen offset:0 sc1 lds
buffer_load_dwordx4 v1, s[52:55], s6 offen offset:1024 sc1 lds
buffer_load_dwordx4 v1, s[52:55], s6 offen offset:2048 sc1 lds
buffer_load_dwordx4 v1, s[52:55], s6 offen offset:3072 sc1 lds
s_mov_b32 m0, 69632
s_add_u32 s6, s4, 12288
buffer_load_dwordx4 v1, s[52:55], s6 offen offset:0 sc1 lds
buffer_load_dwordx4 v1, s[52:55], s6 offen offset:1024 sc1 lds
buffer_load_dwordx4 v1, s[52:55], s6 offen offset:2048 sc1 lds
buffer_load_dwordx4 v1, s[52:55], s6 offen offset:3072 sc1 lds
s_mov_b32 m0, 73728
s_add_u32 s6, s4, 16384
buffer_load_dwordx4 v1, s[52:55], s6 offen offset:0 sc1 lds
buffer_load_dwordx4 v1, s[52:55], s6 offen offset:1024 sc1 lds
buffer_load_dwordx4 v1, s[52:55], s6 offen offset:2048 sc1 lds
buffer_load_dwordx4 v1, s[52:55], s6 offen offset:3072 sc1 lds
s_mov_b32 m0, 77824
s_add_u32 s6, s4, 20480
buffer_load_dwordx4 v1, s[52:55], s6 offen offset:0 sc1 lds
buffer_load_dwordx4 v1, s[52:55], s6 offen offset:1024 sc1 lds
s_waitcnt vmcnt(14)
s_barrier
s_add_u32 s4, s23, 4
s_mul_i32 s4, s4, 57344
s_add_u32 s4, s4, 0x1000000
s_mov_b32 m0, 79872
s_add_u32 s6, s4, 22528
buffer_load_dwordx4 v1, s[52:55], s6 offen offset:0 sc1 lds
buffer_load_dwordx4 v1, s[52:55], s6 offen offset:1024 sc1 lds
buffer_load_dwordx4 v1, s[52:55], s6 offen offset:2048 sc1 lds
buffer_load_dwordx4 v1, s[52:55], s6 offen offset:3072 sc1 lds
s_mov_b32 m0, 94208
s_add_u32 s6, s4, 36864
buffer_load_dwordx4 v1, s[52:55], s6 offen offset:0 sc1 lds
buffer_load_dwordx4 v1, s[52:55], s6 offen offset:1024 sc1 lds
buffer_load_dwordx4 v1, s[52:55], s6 offen offset:2048 sc1 lds
buffer_load_dwordx4 v1, s[52:55], s6 offen offset:3072 sc1 lds
s_mov_b32 m0, 98304
s_add_u32 s6, s4, 40960
buffer_load_dwordx4 v1, s[52:55], s6 offen offset:0 sc1 lds
buffer_load_dwordx4 v1, s[52:55], s6 offen offset:1024 sc1 lds
buffer_load_dwordx4 v1, s[52:55], s6 offen offset:2048 sc1 lds
buffer_load_dwordx4 v1, s[52:55], s6 offen offset:3072 sc1 lds
s_mov_b32 m0, 83968
s_add_u32 s6, s4, 26624
buffer_load_dwordx4 v1, s[52:55], s6 offen offset:0 sc1 lds
buffer_load_dwordx4 v1, s[52:55], s6 offen offset:1024 sc1 lds
s_waitcnt vmcnt(14)
s_barrier
s_add_u32 s4, s23, 4
s_mul_i32 s4, s4, 57344
s_add_u32 s4, s4, 0x1000000
s_mov_b32 m0, 86016
s_add_u32 s6, s4, 28672
buffer_load_dwordx4 v1, s[52:55], s6 offen offset:0 sc1 lds
buffer_load_dwordx4 v1, s[52:55], s6 offen offset:1024 sc1 lds
buffer_load_dwordx4 v1, s[52:55], s6 offen offset:2048 sc1 lds
buffer_load_dwordx4 v1, s[52:55], s6 offen offset:3072 sc1 lds
s_mov_b32 m0, 90112
s_add_u32 s6, s4, 32768
buffer_load_dwordx4 v1, s[52:55], s6 offen offset:0 sc1 lds
buffer_load_dwordx4 v1, s[52:55], s6 offen offset:1024 sc1 lds
buffer_load_dwordx4 v1, s[52:55], s6 offen offset:2048 sc1 lds
buffer_load_dwordx4 v1, s[52:55], s6 offen offset:3072 sc1 lds
s_mov_b32 m0, 102400
s_add_u32 s6, s4, 45056
buffer_load_dwordx4 v1, s[52:55], s6 offen offset:0 sc1 lds
buffer_load_dwordx4 v1, s[52:55], s6 offen offset:1024 sc1 lds
buffer_load_dwordx4 v1, s[52:55], s6 offen offset:2048 sc1 lds
buffer_load_dwordx4 v1, s[52:55], s6 offen offset:3072 sc1 lds
s_mov_b32 m0, 106496
s_add_u32 s6, s4, 49152
buffer_load_dwordx4 v1, s[52:55], s6 offen offset:0 sc1 lds
buffer_load_dwordx4 v1, s[52:55], s6 offen offset:1024 sc1 lds
s_waitcnt vmcnt(14)
s_barrier
s_waitcnt vmcnt(0)
s_barrier
L_end:
s_endpgm
L_code_end:
.section .rodata,"a"
.p2align 6
.amdhsa_kernel sequential_preLN__sliding_block__swiglu_ffn__prompt_kernel
  .amdhsa_next_free_vgpr 256
  .amdhsa_next_free_sgpr 102
  .amdhsa_accum_offset 256
  .amdhsa_group_segment_fixed_size 0
  .amdhsa_kernarg_size 80
  .amdhsa_user_sgpr_count 2
  .amdhsa_user_sgpr_kernarg_segment_ptr 1
  .amdhsa_system_sgpr_workgroup_id_x 1
.end_amdhsa_kernel
```
